```python
import torch

def _softmax(x, axis=-1):
    return torch.softmax(x, dim=axis)
def _gelu(x):
    return torch.nn.functional.gelu(x, approximate="tanh")
def _silu(x):
    return torch.nn.functional.silu(x)
def _sigmoid(x):
    return torch.sigmoid(x)
def _layernorm(x, axis=-1, eps=1e-5):
    m = x.mean(dim=axis, keepdim=True)
    v = x.var(dim=axis, keepdim=True, unbiased=False)
    return (x - m) / torch.sqrt(v + eps)
def _scatter_add(tgt, idx, src, axis=0):
    return tgt.clone().index_add_(axis, idx, src)
def _segment_sum(src, seg, n):
    out = torch.zeros((n,) + src.shape[1:], dtype=src.dtype)
    return out.index_add_(0, seg, src)
def _pad(x, pw):
    flat = tuple(v for pair in reversed(pw) for v in pair)
    return torch.nn.functional.pad(x, flat)

kernel_name = 'concat_heads__linear_attn_block__linear_attn_block__prompt'

def setup_inputs():

    _w = (lambda a: (lambda t: t.to(torch.bfloat16) if t.is_floating_point() else t)(torch.as_tensor(a)))
    def _A_setup():
        B, S, D = 1, 2048, 512
        return {
            "x": _w((lambda *s: torch.randn(*s, dtype=torch.bfloat16) * 0.05)(B, S, D)),
            "wqkv": _w((lambda *s: torch.randn(*s, dtype=torch.bfloat16) * 0.4)(D, 3 * D)),
            "wo": _w((lambda *s: torch.randn(*s, dtype=torch.bfloat16) * 0.05)(D, D)),
        }
    _A_in = _A_setup()

    def _B_setup():
        B, S, D = 1, 2048, 512
        return {
            "x": _w((lambda *s: torch.randn(*s, dtype=torch.bfloat16) * 0.05)(B, S, D)),
            "wqkv": _w((lambda *s: torch.randn(*s, dtype=torch.bfloat16) * 0.4)(D, 3 * D)),
            "wo": _w((lambda *s: torch.randn(*s, dtype=torch.bfloat16) * 0.05)(D, D)),
        }
    _B_in = _B_setup()

    return {
        "A_x": _A_in["x"],
        "A_wqkv": _A_in["wqkv"],
        "A_wo": _A_in["wo"],
        "B_x": _B_in["x"],
        "B_wqkv": _B_in["wqkv"],
        "B_wo": _B_in["wo"],
    }

def reference(A_x, A_wqkv, A_wo, B_x, B_wqkv, B_wo):
    def _A_ref(x, wqkv, wo):
        B, S, D = x.shape
        H = 32; Dh = D // H
        qkv = (lambda x, *d: x.permute(*d))((x @ wqkv).reshape(B, S, 3, H, Dh), 2, 0, 3, 1, 4)
        q, k, v = qkv[0], qkv[1], qkv[2]
        phi = lambda t: torch.where(t > 0, t + 1, torch.exp(t)) + 1e-6
        pq, pk = phi(q), phi(k)
        kv = torch.einsum("bhsd,bhse->bhde", pk, v)
        z = torch.einsum("bhsd->bhd", pk)
        num = torch.einsum("bhqd,bhde->bhqe", pq, kv)
        den = torch.einsum("bhqd,bhd->bhq", pq, z)[..., None] + 1e-6
        o = num / den
        return (lambda x, *d: x.permute(*d))(o, 0, 2, 1, 3).reshape(B, S, D) @ wo

    def _B_ref(x, wqkv, wo):
        B, S, D = x.shape
        H = 32; Dh = D // H
        qkv = (lambda x, *d: x.permute(*d))((x @ wqkv).reshape(B, S, 3, H, Dh), 2, 0, 3, 1, 4)
        q, k, v = qkv[0], qkv[1], qkv[2]
        phi = lambda t: torch.where(t > 0, t + 1, torch.exp(t)) + 1e-6
        pq, pk = phi(q), phi(k)
        kv = torch.einsum("bhsd,bhse->bhde", pk, v)
        z = torch.einsum("bhsd->bhd", pk)
        num = torch.einsum("bhqd,bhde->bhqe", pq, kv)
        den = torch.einsum("bhqd,bhd->bhq", pq, z)[..., None] + 1e-6
        o = num / den
        return (lambda x, *d: x.permute(*d))(o, 0, 2, 1, 3).reshape(B, S, D) @ wo

    a = _A_ref(A_x, A_wqkv, A_wo)
    b = _B_ref(B_x, B_wqkv, B_wo)
    return torch.concatenate([a, b], axis=-1)
```

```asm
; @launch grid=(256,1,1) block=(256,1,1) lds=163840
.amdgcn_target "amdgcn-amd-amdhsa--gfx950"
.text
.globl concat_heads__linear_attn_block__linear_attn_block__prompt_kernel
.p2align 8
.type concat_heads__linear_attn_block__linear_attn_block__prompt_kernel,@function
concat_heads__linear_attn_block__linear_attn_block__prompt_kernel:
s_cmp_ge_u32 s2, 256
s_cbranch_scc1 L_end
s_load_dwordx16 s[4:19], s[0:1], 0
s_load_dwordx2 s[20:21], s[0:1], 64
s_getpc_b64 s[22:23]
L_pc:
s_lshr_b32 s48, s2, 3
s_lshl_b32 s48, s48, 2
v_lshrrev_b32 v33, 6, v0
v_add_u32 v33, s48, v33
v_mul_u32_u24 v33, 256, v33
v_and_b32 v34, 63, v0
v_lshl_add_u32 v33, v34, 7, v33
v_min_u32 v33, L_code_end-L_pc-4, v33
s_mov_b64 exec, 3
global_load_dword v253, v33, s[22:23]
s_mov_b64 exec, -1
v_lshrrev_b32 v32, 6, v0
v_and_b32 v1, 63, v0
v_readfirstlane_b32 s47, v32
s_and_b32 s44, s2, 1
s_lshr_b32 s48, s2, 3
s_and_b32 s49, s48, 7
s_lshr_b32 s55, s48, 3
s_bfe_u32 s50, s2, 0x20001
s_lshl_b32 s45, s50, 2
s_add_u32 s45, s45, s55
s_add_u32 s46, s49, 0
s_and_b32 s46, s46, 7
s_lshl_b32 s54, s50, 3
s_add_u32 s54, s54, s49
s_mul_i32 s49, s49, 4
s_mul_i32 s50, s55, 4
s_add_u32 s99, s49, s50
s_bfe_u32 s50, s2, 0x20001
s_mul_i32 s50, s50, 2
s_add_u32 s99, s99, s50
s_and_b32 s99, s99, 7
v_lshrrev_b32 v2, 4, v1
v_and_b32 v3, 15, v0
s_lshl_b32 s100, s47, 12
v_lshrrev_b32 v32, 3, v1
v_lshlrev_b32 v32, 10, v32
v_and_b32 v33, 7, v1
v_xor_b32 v33, v33, v2
s_lshl_b32 s48, s45, 17
s_lshl_b32 s49, s47, 15
s_add_u32 s48, s48, s49
v_lshl_add_u32 v56, v33, 4, v32
v_add_u32 v56, s48, v56
v_xor_b32 v57, 64, v56
v_add_u32 v57, 7168, v57
v_add_u32 v58, 14336, v56
v_add_u32 v59, 14336, v57
v_lshrrev_b32 v33, 1, v3
v_xor_b32 v33, v2, v33
v_lshrrev_b32 v34, 2, v33
v_lshlrev_b32 v34, 10, v34
v_and_b32 v35, 3, v33
v_lshl_add_u32 v34, v35, 5, v34
v_and_b32 v35, 1, v3
v_lshl_add_u32 v34, v35, 4, v34
v_xor_b32 v37, 1024, v34
s_lshl_b32 s50, s47, 4
v_add_u32 v36, s50, v2
v_mul_u32_u24 v36, 3072, v36
s_lshl_b32 s50, s46, 7
s_add_u32 s51, s50, 1024
v_add3_u32 v60, v36, v34, s51
v_add_u32 v61, 11264, v60
s_add_u32 s51, s51, 22528
v_add3_u32 v62, v36, v37, s51
v_add_u32 v63, 11264, v62
s_lshl_b32 s48, s99, 7
s_mul_i32 s49, s99, 196608
s_mov_b32 m0, s100
s_waitcnt lgkmcnt(0)
s_cmp_eq_u32 s44, 0
s_cselect_b32 s24, s4, s10
s_cselect_b32 s25, s5, s11
s_mov_b32 s26, 2097152
s_mov_b32 s27, 0x20000
s_cselect_b32 s28, s6, s12
s_cselect_b32 s29, s7, s13
s_mov_b32 s30, 1572864
s_mov_b32 s31, 0x20000
buffer_load_dwordx4 v56, s[24:27], s48 offen offset:0  lds
buffer_load_dwordx4 v57, s[24:27], s48 offen offset:1024  lds
buffer_load_dwordx4 v58, s[24:27], s48 offen offset:2048  lds
buffer_load_dwordx4 v59, s[24:27], s48 offen offset:3072  lds
s_add_u32 m0, s100, 16384
s_nop 0
buffer_load_dwordx4 v60, s[28:31], s49 offen offset:0  lds
buffer_load_dwordx4 v61, s[28:31], s49 offen offset:1024  lds
buffer_load_dwordx4 v62, s[28:31], s49 offen offset:2048  lds
buffer_load_dwordx4 v63, s[28:31], s49 offen offset:3072  lds
s_cmp_eq_u32 s44, 0
s_cselect_b32 s32, s8, s14
s_cselect_b32 s33, s9, s15
s_mov_b32 s34, 524288
s_mov_b32 s35, 0x20000
s_mov_b32 s36, s16
s_mov_b32 s37, s17
s_mov_b32 s38, 4194304
s_mov_b32 s39, 0x20000
s_mov_b32 s40, s20
s_mov_b32 s41, s21
s_mov_b32 s42, 8388608
s_mov_b32 s43, 0x20000
s_add_u32 s48, s99, 0
s_and_b32 s48, s48, 7
s_lshl_b32 s4, s48, 7
s_mul_i32 s12, s48, 196608
s_add_u32 s48, s99, 1
s_and_b32 s48, s48, 7
s_lshl_b32 s5, s48, 7
s_mul_i32 s13, s48, 196608
s_add_u32 s48, s99, 2
s_and_b32 s48, s48, 7
s_lshl_b32 s6, s48, 7
s_mul_i32 s14, s48, 196608
s_add_u32 s48, s99, 3
s_and_b32 s48, s48, 7
s_lshl_b32 s7, s48, 7
s_mul_i32 s15, s48, 196608
s_add_u32 s48, s99, 4
s_and_b32 s48, s48, 7
s_lshl_b32 s8, s48, 7
s_mul_i32 s16, s48, 196608
s_add_u32 s48, s99, 5
s_and_b32 s48, s48, 7
s_lshl_b32 s9, s48, 7
s_mul_i32 s17, s48, 196608
s_add_u32 s48, s99, 6
s_and_b32 s48, s48, 7
s_lshl_b32 s10, s48, 7
s_mul_i32 s18, s48, 196608
s_add_u32 s48, s99, 7
s_and_b32 s48, s48, 7
s_lshl_b32 s11, s48, 7
s_mul_i32 s19, s48, 196608
s_add_u32 m0, s100, 32768
s_nop 0
buffer_load_dwordx4 v56, s[24:27], s5 offen offset:0  lds
buffer_load_dwordx4 v57, s[24:27], s5 offen offset:1024  lds
buffer_load_dwordx4 v58, s[24:27], s5 offen offset:2048  lds
buffer_load_dwordx4 v59, s[24:27], s5 offen offset:3072  lds
s_add_u32 m0, s100, 49152
s_nop 0
buffer_load_dwordx4 v60, s[28:31], s13 offen offset:0  lds
buffer_load_dwordx4 v61, s[28:31], s13 offen offset:1024  lds
buffer_load_dwordx4 v62, s[28:31], s13 offen offset:2048  lds
buffer_load_dwordx4 v63, s[28:31], s13 offen offset:3072  lds
s_mov_b32 s52, 16384
s_mov_b32 s3, 4096
s_mov_b32 s93, 32768
s_mov_b32 s20, 8192
s_mov_b32 s21, 12288
s_lshl_b32 s22, s47, 11
s_lshl_b32 s23, s47, 10
s_mov_b32 s56, 0x3fb8aa3b
s_mov_b32 s57, 0x3fb8aa3b
s_mov_b32 s58, 0x3f800008
s_mov_b32 s59, 0x3f800008
s_mov_b32 s60, 0x358637bd
s_mov_b32 s61, 0x358637bd
v_lshrrev_b32 v32, 1, v3
v_xor_b32 v32, v32, v2
v_lshlrev_b32 v33, 7, v3
v_lshl_add_u32 v32, v32, 4, v33
v_add_u32 v24, s100, v32
v_xor_b32 v25, 64, v24
v_lshrrev_b32 v32, 2, v3
v_and_b32 v33, 3, v3
v_and_b32 v34, 1, v2
v_lshl_add_u32 v34, v34, 2, v32
v_lshl_add_u32 v35, v2, 3, v32
v_lshlrev_b32 v36, 8, v35
v_lshl_add_u32 v36, v33, 3, v36
v_xor_b32 v37, 0, v34
v_lshl_add_u32 v4, v37, 5, v36
v_xor_b32 v37, 1, v34
v_lshl_add_u32 v5, v37, 5, v36
v_xor_b32 v37, 2, v34
v_lshl_add_u32 v6, v37, 5, v36
v_xor_b32 v37, 3, v34
v_lshl_add_u32 v7, v37, 5, v36
v_xor_b32 v37, 4, v34
v_lshl_add_u32 v8, v37, 5, v36
v_xor_b32 v37, 5, v34
v_lshl_add_u32 v9, v37, 5, v36
v_xor_b32 v37, 6, v34
v_lshl_add_u32 v10, v37, 5, v36
v_xor_b32 v37, 7, v34
v_lshl_add_u32 v11, v37, 5, v36
v_lshlrev_b32 v36, 7, v35
v_lshl_add_u32 v36, v33, 3, v36
v_lshrrev_b32 v37, 1, v32
v_and_b32 v38, 1, v2
v_lshl_add_u32 v37, v38, 1, v37
v_add_u32 v36, 98304, v36
v_xor_b32 v38, 0, v37
v_lshl_add_u32 v12, v38, 5, v36
v_xor_b32 v38, 1, v37
v_lshl_add_u32 v13, v38, 5, v36
v_xor_b32 v38, 2, v37
v_lshl_add_u32 v14, v38, 5, v36
v_xor_b32 v38, 3, v37
v_lshl_add_u32 v15, v38, 5, v36
v_lshl_add_u32 v35, v2, 2, v32
v_lshlrev_b32 v36, 7, v35
v_lshl_add_u32 v36, v33, 3, v36
v_add_u32 v36, 32768, v36
v_xor_b32 v38, 0, v37
v_lshl_add_u32 v16, v38, 5, v36
v_xor_b32 v38, 1, v37
v_lshl_add_u32 v17, v38, 5, v36
v_xor_b32 v38, 2, v37
v_lshl_add_u32 v18, v38, 5, v36
v_xor_b32 v38, 3, v37
v_lshl_add_u32 v19, v38, 5, v36
v_lshrrev_b32 v32, 3, v3
v_lshl_add_u32 v32, v2, 1, v32
s_lshl_b32 s51, s47, 4
v_add_u32 v32, s51, v32
v_mul_u32_u24 v32, 3072, v32
v_bfe_u32 v33, v3, 1, 2
v_and_b32 v34, 1, v2
v_xor_b32 v33, v33, v34
v_lshlrev_b32 v33, 5, v33
v_and_b32 v35, 1, v3
v_lshl_add_u32 v33, v35, 4, v33
v_xor_b32 v34, 64, v33
s_lshl_b32 s50, s46, 7
v_add3_u32 v26, v32, v33, s50
s_add_u32 s50, s50, 23552
v_add3_u32 v27, v32, v34, s50
v_lshrrev_b32 v32, 3, v3
v_lshl_add_u32 v32, v2, 1, v32
v_add_u32 v32, s51, v32
v_lshlrev_b32 v32, 10, v32
v_bfe_u32 v33, v3, 1, 2
v_xor_b32 v33, v33, v2
v_lshl_add_u32 v32, v33, 5, v32
v_lshl_add_u32 v32, v35, 4, v32
s_lshl_b32 s48, s46, 7
v_add_u32 v28, s48, v32
v_add_u32 v29, 7168, v28
s_lshr_b32 s48, s2, 3
s_lshl_b32 s48, s48, 2
s_add_u32 s48, s48, s47
s_lshl_b32 s48, s48, 2
v_add_u32 v32, s48, v2
v_lshlrev_b32 v33, 6, v3
v_lshl_add_u32 v43, v32, 10, v33
v_mul_u32_u24 v32, 3072, v32
v_add_u32 v42, v32, v33
s_lshl_b32 s48, s44, 21
s_lshl_b32 s49, s45, 17
s_add_u32 s48, s48, s49
s_lshl_b32 s49, s47, 15
s_add_u32 s48, s48, s49
s_lshl_b32 s49, s46, 11
s_add_u32 s48, s48, s49
v_lshl_add_u32 v240, v1, 4, s48
s_lshl_b32 s48, s44, 4
s_add_u32 s48, s48, s45
s_lshl_b32 s49, s48, 2
s_add_u32 s49, s49, s47
s_lshl_b32 s49, s49, 11
s_add_u32 s49, s49, 7340032
v_lshl_add_u32 v45, v1, 2, s49
s_lshl_b32 s50, s46, 8
v_add_u32 v241, s50, v45
s_lshl_b32 s48, s48, 10
s_add_u32 s48, s48, 7864320
v_and_b32 v243, 7, v1
v_lshl_add_u32 v243, v243, 7, s48
s_lshl_b32 s49, s46, 7
s_add_u32 s48, s48, s49
s_lshl_b32 s49, s47, 2
s_add_u32 s94, s48, s49
s_getreg_b32 s95, hwreg(HW_REG_XCC_ID)
s_and_b32 s95, s95, 15
s_lshl_b32 s48, s44, 7
s_add_u32 s48, s48, 5324800
v_mov_b32 v51, 0
buffer_load_dword v30, v51, s[40:43], s48 offen sc1
v_lshlrev_b32 v252, 4, v1
v_mov_b32 v254, 0
v_mov_b32 v49, 0xff
v_cmp_eq_u32 s[90:91], 0, v3
v_add_u32 v245, s100, v252
s_lshl_b32 s48, s47, 8
s_add_u32 s48, s48, 16384
v_lshl_add_u32 v246, v2, 4, s48
v_add_u32 v247, s23, v252
s_lshl_b32 s48, s47, 6
s_add_u32 s48, s48, 16384
v_lshl_add_u32 v248, v2, 4, s48
s_add_u32 s48, s23, 20480
v_add_u32 v251, s48, v252
s_lshl_b32 s48, s44, 3
s_add_u32 s48, s48, s46
s_lshl_b32 s48, s48, 2
s_add_u32 s48, s48, s47
s_lshl_b32 s49, s48, 14
s_add_u32 s49, s49, 4194304
s_lshl_b32 s50, s48, 10
s_add_u32 s50, s50, 5242880
v_add_u32 v46, s49, v252
s_lshl_b32 s49, s45, 10
v_add_u32 v250, s49, v46
v_lshlrev_b32 v47, 6, v3
v_lshl_add_u32 v47, v2, 4, v47
v_add_u32 v47, s50, v47
s_lshl_b32 s51, s45, 6
s_add_u32 s50, s50, s51
v_lshl_add_u32 v249, v2, 4, s50
v_readfirstlane_b32 s48, v240
v_readfirstlane_b32 s49, v241
v_and_b32 v32, 1, v2
v_lshlrev_b32 v159, 14, v32
v_lshl_add_u32 v159, v3, 7, v159
v_add_u32 v159, s48, v159
v_and_b32 v33, 1, v1
v_lshl_add_u32 v32, v33, 7, s49
v_cmp_gt_u32 vcc, 32, v1
s_nop 1
v_cndmask_b32 v159, v32, v159, vcc
v_mov_b32 v32, 0x3f803f80
v_accvgpr_write_b32 a128, v32
v_accvgpr_write_b32 a129, v32
v_accvgpr_write_b32 a130, v32
v_accvgpr_write_b32 a131, v32
s_lshl_b32 s49, s46, 11
v_subrev_u32 v44, s49, v240
v_add_u32 v255, 16384, v44
s_lshl_b32 s48, s45, 18
s_lshl_b32 s49, s47, 16
s_add_u32 s48, s48, s49
s_lshl_b32 s49, s44, 10
s_add_u32 s48, s48, s49
s_lshl_b32 s49, s46, 7
s_add_u32 s48, s48, s49
v_lshlrev_b32 v31, 11, v3
v_and_b32 v32, 1, v2
v_lshl_add_u32 v31, v32, 5, v31
v_lshrrev_b32 v32, 1, v2
v_lshl_add_u32 v31, v32, 4, v31
v_add_u32 v31, s48, v31
s_mov_b32 s62, 0
s_mov_b32 s98, 0
s_add_u32 m0, s100, 65536
s_nop 0
buffer_load_dwordx4 v56, s[24:27], s6 offen offset:0  lds
buffer_load_dwordx4 v57, s[24:27], s6 offen offset:1024  lds
buffer_load_dwordx4 v58, s[24:27], s6 offen offset:2048  lds
buffer_load_dwordx4 v59, s[24:27], s6 offen offset:3072  lds
s_add_u32 m0, s100, 81920
s_nop 0
buffer_load_dwordx4 v60, s[28:31], s14 offen offset:0  lds
buffer_load_dwordx4 v61, s[28:31], s14 offen offset:1024  lds
buffer_load_dwordx4 v62, s[28:31], s14 offen offset:2048  lds
buffer_load_dwordx4 v63, s[28:31], s14 offen offset:3072  lds
s_waitcnt vmcnt(17)
s_barrier
ds_read_b128 a[0:3], v24 offset:0
ds_read_b128 a[4:7], v24 offset:2048
ds_read_b64_tr_b16 v[160:161], v4 offset:16384
ds_read_b64_tr_b16 v[162:163], v4 offset:17408
ds_read_b64_tr_b16 v[164:165], v5 offset:16384
ds_read_b64_tr_b16 v[166:167], v5 offset:17408
ds_read_b128 a[8:11], v25 offset:0
ds_read_b128 a[12:15], v25 offset:2048
ds_read_b64_tr_b16 v[168:169], v6 offset:16384
ds_read_b64_tr_b16 v[170:171], v6 offset:17408
ds_read_b64_tr_b16 v[172:173], v7 offset:16384
ds_read_b64_tr_b16 v[174:175], v7 offset:17408
ds_read_b64_tr_b16 v[176:177], v8 offset:16384
ds_read_b64_tr_b16 v[178:179], v8 offset:17408
ds_read_b64_tr_b16 v[180:181], v9 offset:16384
ds_read_b64_tr_b16 v[182:183], v9 offset:17408
s_waitcnt lgkmcnt(10)
ds_read_b64_tr_b16 v[184:185], v10 offset:16384
v_mfma_f32_16x16x32_bf16 v[64:67], a[0:3], v[160:163], 0
ds_read_b64_tr_b16 v[186:187], v10 offset:17408
v_mfma_f32_16x16x32_bf16 v[96:99], a[4:7], v[160:163], 0
ds_read_b64_tr_b16 v[188:189], v11 offset:16384
v_mfma_f32_16x16x32_bf16 v[68:71], a[0:3], v[164:167], 0
ds_read_b64_tr_b16 v[190:191], v11 offset:17408
s_waitcnt lgkmcnt(8)
v_mfma_f32_16x16x32_bf16 v[100:103], a[4:7], v[164:167], 0
ds_read_b64_tr_b16 v[192:193], v4 offset:24576
v_mfma_f32_16x16x32_bf16 v[72:75], a[0:3], v[168:171], 0
ds_read_b64_tr_b16 v[194:195], v4 offset:25600
v_mfma_f32_16x16x32_bf16 v[104:107], a[4:7], v[168:171], 0
ds_read_b64_tr_b16 v[196:197], v5 offset:24576
v_mfma_f32_16x16x32_bf16 v[76:79], a[0:3], v[172:175], 0
ds_read_b64_tr_b16 v[198:199], v5 offset:25600
s_waitcnt lgkmcnt(8)
v_mfma_f32_16x16x32_bf16 v[108:111], a[4:7], v[172:175], 0
ds_read_b64_tr_b16 v[200:201], v6 offset:24576
v_mfma_f32_16x16x32_bf16 v[80:83], a[0:3], v[176:179], 0
ds_read_b64_tr_b16 v[202:203], v6 offset:25600
v_mfma_f32_16x16x32_bf16 v[112:115], a[4:7], v[176:179], 0
ds_read_b64_tr_b16 v[204:205], v7 offset:24576
v_mfma_f32_16x16x32_bf16 v[84:87], a[0:3], v[180:183], 0
ds_read_b64_tr_b16 v[206:207], v7 offset:25600
s_waitcnt lgkmcnt(8)
v_mfma_f32_16x16x32_bf16 v[116:119], a[4:7], v[180:183], 0
ds_read_b64_tr_b16 v[208:209], v8 offset:24576
v_mfma_f32_16x16x32_bf16 v[88:91], a[0:3], v[184:187], 0
ds_read_b64_tr_b16 v[210:211], v8 offset:25600
v_mfma_f32_16x16x32_bf16 v[120:123], a[4:7], v[184:187], 0
ds_read_b64_tr_b16 v[212:213], v9 offset:24576
v_mfma_f32_16x16x32_bf16 v[92:95], a[0:3], v[188:191], 0
ds_read_b64_tr_b16 v[214:215], v9 offset:25600
s_waitcnt lgkmcnt(8)
v_mfma_f32_16x16x32_bf16 v[124:127], a[4:7], v[188:191], 0
ds_read_b64_tr_b16 v[216:217], v10 offset:24576
v_mfma_f32_16x16x32_bf16 v[64:67], a[8:11], v[192:195], v[64:67]
ds_read_b64_tr_b16 v[218:219], v10 offset:25600
v_mfma_f32_16x16x32_bf16 v[96:99], a[12:15], v[192:195], v[96:99]
ds_read_b64_tr_b16 v[220:221], v11 offset:24576
v_mfma_f32_16x16x32_bf16 v[68:71], a[8:11], v[196:199], v[68:71]
ds_read_b64_tr_b16 v[222:223], v11 offset:25600
s_waitcnt lgkmcnt(8)
v_mfma_f32_16x16x32_bf16 v[100:103], a[12:15], v[196:199], v[100:103]
s_waitcnt vmcnt(9)
s_barrier
ds_read_b64_tr_b16 v[160:161], v4 offset:49152
v_mfma_f32_16x16x32_bf16 v[72:75], a[8:11], v[200:203], v[72:75]
ds_read_b128 a[16:19], v24 offset:32768
ds_read_b64_tr_b16 v[162:163], v4 offset:50176
v_mfma_f32_16x16x32_bf16 v[104:107], a[12:15], v[200:203], v[104:107]
ds_read_b64_tr_b16 v[164:165], v5 offset:49152
s_add_u32 m0, s100, 98304
v_mfma_f32_16x16x32_bf16 v[76:79], a[8:11], v[204:207], v[76:79]
ds_read_b128 a[20:23], v24 offset:34816
ds_read_b64_tr_b16 v[166:167], v5 offset:50176
s_waitcnt lgkmcnt(10)
v_mfma_f32_16x16x32_bf16 v[108:111], a[12:15], v[204:207], v[108:111]
ds_read_b64_tr_b16 v[168:169], v6 offset:49152
buffer_load_dwordx4 v56, s[24:27], s7 offen offset:0  lds
v_mfma_f32_16x16x32_bf16 v[80:83], a[8:11], v[208:211], v[80:83]
ds_read_b64_tr_b16 v[170:171], v6 offset:50176
v_mfma_f32_16x16x32_bf16 v[112:115], a[12:15], v[208:211], v[112:115]
ds_read_b64_tr_b16 v[172:173], v7 offset:49152
buffer_load_dwordx4 v57, s[24:27], s7 offen offset:1024  lds
v_mfma_f32_16x16x32_bf16 v[84:87], a[8:11], v[212:215], v[84:87]
ds_read_b64_tr_b16 v[174:175], v7 offset:50176
s_waitcnt lgkmcnt(10)
v_mfma_f32_16x16x32_bf16 v[116:119], a[12:15], v[212:215], v[116:119]
ds_read_b64_tr_b16 v[176:177], v8 offset:49152
buffer_load_dwordx4 v58, s[24:27], s7 offen offset:2048  lds
v_mfma_f32_16x16x32_bf16 v[88:91], a[8:11], v[216:219], v[88:91]
ds_read_b64_tr_b16 v[178:179], v8 offset:50176
v_mfma_f32_16x16x32_bf16 v[120:123], a[12:15], v[216:219], v[120:123]
ds_read_b64_tr_b16 v[180:181], v9 offset:49152
buffer_load_dwordx4 v59, s[24:27], s7 offen offset:3072  lds
v_mfma_f32_16x16x32_bf16 v[92:95], a[8:11], v[220:223], v[92:95]
ds_read_b128 a[24:27], v25 offset:32768
ds_read_b64_tr_b16 v[182:183], v9 offset:50176
s_waitcnt lgkmcnt(9)
v_mfma_f32_16x16x32_bf16 v[124:127], a[12:15], v[220:223], v[124:127]
ds_read_b64_tr_b16 v[184:185], v10 offset:49152
s_add_u32 m0, s100, 114688
v_mfma_f32_16x16x32_bf16 v[64:67], a[16:19], v[160:163], v[64:67]
ds_read_b128 a[28:31], v25 offset:34816
ds_read_b64_tr_b16 v[186:187], v10 offset:50176
v_mfma_f32_16x16x32_bf16 v[96:99], a[20:23], v[160:163], v[96:99]
ds_read_b64_tr_b16 v[188:189], v11 offset:49152
buffer_load_dwordx4 v60, s[28:31], s15 offen offset:0  lds
v_mfma_f32_16x16x32_bf16 v[68:71], a[16:19], v[164:167], v[68:71]
ds_read_b64_tr_b16 v[190:191], v11 offset:50176
s_waitcnt lgkmcnt(10)
v_mfma_f32_16x16x32_bf16 v[100:103], a[20:23], v[164:167], v[100:103]
ds_read_b64_tr_b16 v[192:193], v4 offset:57344
buffer_load_dwordx4 v61, s[28:31], s15 offen offset:1024  lds
v_mfma_f32_16x16x32_bf16 v[72:75], a[16:19], v[168:171], v[72:75]
ds_read_b64_tr_b16 v[194:195], v4 offset:58368
v_mfma_f32_16x16x32_bf16 v[104:107], a[20:23], v[168:171], v[104:107]
ds_read_b64_tr_b16 v[196:197], v5 offset:57344
buffer_load_dwordx4 v62, s[28:31], s15 offen offset:2048  lds
v_mfma_f32_16x16x32_bf16 v[76:79], a[16:19], v[172:175], v[76:79]
ds_read_b64_tr_b16 v[198:199], v5 offset:58368
s_waitcnt lgkmcnt(9)
v_mfma_f32_16x16x32_bf16 v[108:111], a[20:23], v[172:175], v[108:111]
ds_read_b64_tr_b16 v[200:201], v6 offset:57344
buffer_load_dwordx4 v63, s[28:31], s15 offen offset:3072  lds
v_mfma_f32_16x16x32_bf16 v[80:83], a[16:19], v[176:179], v[80:83]
ds_read_b64_tr_b16 v[202:203], v6 offset:58368
v_mfma_f32_16x16x32_bf16 v[112:115], a[20:23], v[176:179], v[112:115]
ds_read_b64_tr_b16 v[204:205], v7 offset:57344
v_mfma_f32_16x16x32_bf16 v[84:87], a[16:19], v[180:183], v[84:87]
ds_read_b64_tr_b16 v[206:207], v7 offset:58368
s_waitcnt lgkmcnt(8)
v_mfma_f32_16x16x32_bf16 v[116:119], a[20:23], v[180:183], v[116:119]
ds_read_b64_tr_b16 v[208:209], v8 offset:57344
v_mfma_f32_16x16x32_bf16 v[88:91], a[16:19], v[184:187], v[88:91]
ds_read_b64_tr_b16 v[210:211], v8 offset:58368
v_mfma_f32_16x16x32_bf16 v[120:123], a[20:23], v[184:187], v[120:123]
ds_read_b64_tr_b16 v[212:213], v9 offset:57344
v_mfma_f32_16x16x32_bf16 v[92:95], a[16:19], v[188:191], v[92:95]
ds_read_b64_tr_b16 v[214:215], v9 offset:58368
s_waitcnt lgkmcnt(8)
v_mfma_f32_16x16x32_bf16 v[124:127], a[20:23], v[188:191], v[124:127]
ds_read_b64_tr_b16 v[216:217], v10 offset:57344
v_mfma_f32_16x16x32_bf16 v[64:67], a[24:27], v[192:195], v[64:67]
ds_read_b64_tr_b16 v[218:219], v10 offset:58368
v_mfma_f32_16x16x32_bf16 v[96:99], a[28:31], v[192:195], v[96:99]
ds_read_b64_tr_b16 v[220:221], v11 offset:57344
v_mfma_f32_16x16x32_bf16 v[68:71], a[24:27], v[196:199], v[68:71]
ds_read_b64_tr_b16 v[222:223], v11 offset:58368
s_waitcnt lgkmcnt(8)
v_mfma_f32_16x16x32_bf16 v[100:103], a[28:31], v[196:199], v[100:103]
s_waitcnt vmcnt(8)
s_barrier
v_add_u32 v4, 0x10000, v4
ds_read_b64_tr_b16 v[160:161], v4 offset:16384
v_mfma_f32_16x16x32_bf16 v[72:75], a[24:27], v[200:203], v[72:75]
v_add_u32 v24, 0x10000, v24
ds_read_b128 a[32:35], v24 offset:0
ds_read_b64_tr_b16 v[162:163], v4 offset:17408
v_mfma_f32_16x16x32_bf16 v[104:107], a[28:31], v[200:203], v[104:107]
v_add_u32 v5, 0x10000, v5
ds_read_b64_tr_b16 v[164:165], v5 offset:16384
v_mfma_f32_16x16x32_bf16 v[76:79], a[24:27], v[204:207], v[76:79]
ds_read_b128 a[36:39], v24 offset:2048
ds_read_b64_tr_b16 v[166:167], v5 offset:17408
s_waitcnt lgkmcnt(10)
v_mfma_f32_16x16x32_bf16 v[108:111], a[28:31], v[204:207], v[108:111]
v_add_u32 v6, 0x10000, v6
ds_read_b64_tr_b16 v[168:169], v6 offset:16384
v_mfma_f32_16x16x32_bf16 v[80:83], a[24:27], v[208:211], v[80:83]
ds_read_b64_tr_b16 v[170:171], v6 offset:17408
s_add_u32 m0, s100, 131072
v_mfma_f32_16x16x32_bf16 v[112:115], a[28:31], v[208:211], v[112:115]
v_add_u32 v7, 0x10000, v7
ds_read_b64_tr_b16 v[172:173], v7 offset:16384
v_mfma_f32_16x16x32_bf16 v[84:87], a[24:27], v[212:215], v[84:87]
ds_read_b64_tr_b16 v[174:175], v7 offset:17408
s_waitcnt lgkmcnt(10)
v_mfma_f32_16x16x32_bf16 v[116:119], a[28:31], v[212:215], v[116:119]
v_add_u32 v8, 0x10000, v8
ds_read_b64_tr_b16 v[176:177], v8 offset:16384
v_mfma_f32_16x16x32_bf16 v[88:91], a[24:27], v[216:219], v[88:91]
ds_read_b64_tr_b16 v[178:179], v8 offset:17408
buffer_load_dwordx4 v56, s[24:27], s8 offen offset:0  lds
v_mfma_f32_16x16x32_bf16 v[120:123], a[28:31], v[216:219], v[120:123]
v_add_u32 v9, 0x10000, v9
ds_read_b64_tr_b16 v[180:181], v9 offset:16384
v_mfma_f32_16x16x32_bf16 v[92:95], a[24:27], v[220:223], v[92:95]
v_add_u32 v25, 0x10000, v25
ds_read_b128 a[40:43], v25 offset:0
ds_read_b64_tr_b16 v[182:183], v9 offset:17408
s_waitcnt lgkmcnt(9)
v_mfma_f32_16x16x32_bf16 v[124:127], a[28:31], v[220:223], v[124:127]
v_add_u32 v10, 0x10000, v10
ds_read_b64_tr_b16 v[184:185], v10 offset:16384
v_mfma_f32_16x16x32_bf16 v[64:67], a[32:35], v[160:163], v[64:67]
ds_read_b128 a[44:47], v25 offset:2048
ds_read_b64_tr_b16 v[186:187], v10 offset:17408
v_mfma_f32_16x16x32_bf16 v[96:99], a[36:39], v[160:163], v[96:99]
v_add_u32 v11, 0x10000, v11
ds_read_b64_tr_b16 v[188:189], v11 offset:16384
v_mfma_f32_16x16x32_bf16 v[68:71], a[32:35], v[164:167], v[68:71]
ds_read_b64_tr_b16 v[190:191], v11 offset:17408
s_waitcnt lgkmcnt(10)
v_mfma_f32_16x16x32_bf16 v[100:103], a[36:39], v[164:167], v[100:103]
ds_read_b64_tr_b16 v[192:193], v4 offset:24576
buffer_load_dwordx4 v57, s[24:27], s8 offen offset:1024  lds
v_mfma_f32_16x16x32_bf16 v[72:75], a[32:35], v[168:171], v[72:75]
ds_read_b64_tr_b16 v[194:195], v4 offset:25600
v_mfma_f32_16x16x32_bf16 v[104:107], a[36:39], v[168:171], v[104:107]
ds_read_b64_tr_b16 v[196:197], v5 offset:24576
buffer_load_dwordx4 v58, s[24:27], s8 offen offset:2048  lds
v_mfma_f32_16x16x32_bf16 v[76:79], a[32:35], v[172:175], v[76:79]
ds_read_b64_tr_b16 v[198:199], v5 offset:25600
s_waitcnt lgkmcnt(9)
v_mfma_f32_16x16x32_bf16 v[108:111], a[36:39], v[172:175], v[108:111]
ds_read_b64_tr_b16 v[200:201], v6 offset:24576
buffer_load_dwordx4 v59, s[24:27], s8 offen offset:3072  lds
v_mfma_f32_16x16x32_bf16 v[80:83], a[32:35], v[176:179], v[80:83]
ds_read_b64_tr_b16 v[202:203], v6 offset:25600
s_add_u32 m0, s100, 147456
v_mfma_f32_16x16x32_bf16 v[112:115], a[36:39], v[176:179], v[112:115]
ds_read_b64_tr_b16 v[204:205], v7 offset:24576
buffer_load_dwordx4 v60, s[28:31], s16 offen offset:0  lds
v_mfma_f32_16x16x32_bf16 v[84:87], a[32:35], v[180:183], v[84:87]
ds_read_b64_tr_b16 v[206:207], v7 offset:25600
s_waitcnt lgkmcnt(8)
v_mfma_f32_16x16x32_bf16 v[116:119], a[36:39], v[180:183], v[116:119]
ds_read_b64_tr_b16 v[208:209], v8 offset:24576
buffer_load_dwordx4 v61, s[28:31], s16 offen offset:1024  lds
v_mfma_f32_16x16x32_bf16 v[88:91], a[32:35], v[184:187], v[88:91]
ds_read_b64_tr_b16 v[210:211], v8 offset:25600
v_mfma_f32_16x16x32_bf16 v[120:123], a[36:39], v[184:187], v[120:123]
ds_read_b64_tr_b16 v[212:213], v9 offset:24576
buffer_load_dwordx4 v62, s[28:31], s16 offen offset:2048  lds
v_mfma_f32_16x16x32_bf16 v[92:95], a[32:35], v[188:191], v[92:95]
ds_read_b64_tr_b16 v[214:215], v9 offset:25600
s_waitcnt lgkmcnt(8)
v_mfma_f32_16x16x32_bf16 v[124:127], a[36:39], v[188:191], v[124:127]
ds_read_b64_tr_b16 v[216:217], v10 offset:24576
buffer_load_dwordx4 v63, s[28:31], s16 offen offset:3072  lds
v_mfma_f32_16x16x32_bf16 v[64:67], a[40:43], v[192:195], v[64:67]
ds_read_b64_tr_b16 v[218:219], v10 offset:25600
s_add_u32 m0, s100, 0
v_mfma_f32_16x16x32_bf16 v[96:99], a[44:47], v[192:195], v[96:99]
ds_read_b64_tr_b16 v[220:221], v11 offset:24576
buffer_load_dwordx4 v56, s[24:27], s9 offen offset:0  lds
v_mfma_f32_16x16x32_bf16 v[68:71], a[40:43], v[196:199], v[68:71]
ds_read_b64_tr_b16 v[222:223], v11 offset:25600
s_waitcnt lgkmcnt(8)
v_mfma_f32_16x16x32_bf16 v[100:103], a[44:47], v[196:199], v[100:103]
s_waitcnt vmcnt(9)
s_barrier
ds_read_b64_tr_b16 v[160:161], v4 offset:49152
v_mfma_f32_16x16x32_bf16 v[72:75], a[40:43], v[200:203], v[72:75]
ds_read_b128 a[48:51], v24 offset:32768
ds_read_b64_tr_b16 v[162:163], v4 offset:50176
v_mfma_f32_16x16x32_bf16 v[104:107], a[44:47], v[200:203], v[104:107]
ds_read_b64_tr_b16 v[164:165], v5 offset:49152
buffer_load_dwordx4 v57, s[24:27], s9 offen offset:1024  lds
v_mfma_f32_16x16x32_bf16 v[76:79], a[40:43], v[204:207], v[76:79]
ds_read_b128 a[52:55], v24 offset:34816
ds_read_b64_tr_b16 v[166:167], v5 offset:50176
s_waitcnt lgkmcnt(10)
v_mfma_f32_16x16x32_bf16 v[108:111], a[44:47], v[204:207], v[108:111]
ds_read_b64_tr_b16 v[168:169], v6 offset:49152
buffer_load_dwordx4 v58, s[24:27], s9 offen offset:2048  lds
v_mfma_f32_16x16x32_bf16 v[80:83], a[40:43], v[208:211], v[80:83]
ds_read_b64_tr_b16 v[170:171], v6 offset:50176
v_mfma_f32_16x16x32_bf16 v[112:115], a[44:47], v[208:211], v[112:115]
ds_read_b64_tr_b16 v[172:173], v7 offset:49152
buffer_load_dwordx4 v59, s[24:27], s9 offen offset:3072  lds
v_mfma_f32_16x16x32_bf16 v[84:87], a[40:43], v[212:215], v[84:87]
ds_read_b64_tr_b16 v[174:175], v7 offset:50176
s_waitcnt lgkmcnt(10)
v_mfma_f32_16x16x32_bf16 v[116:119], a[44:47], v[212:215], v[116:119]
ds_read_b64_tr_b16 v[176:177], v8 offset:49152
s_add_u32 m0, s100, 16384
v_mfma_f32_16x16x32_bf16 v[88:91], a[40:43], v[216:219], v[88:91]
ds_read_b64_tr_b16 v[178:179], v8 offset:50176
buffer_load_dwordx4 v60, s[28:31], s17 offen offset:0  lds
v_mfma_f32_16x16x32_bf16 v[120:123], a[44:47], v[216:219], v[120:123]
ds_read_b64_tr_b16 v[180:181], v9 offset:49152
v_mfma_f32_16x16x32_bf16 v[92:95], a[40:43], v[220:223], v[92:95]
ds_read_b128 a[56:59], v25 offset:32768
ds_read_b64_tr_b16 v[182:183], v9 offset:50176
s_waitcnt lgkmcnt(9)
v_mfma_f32_16x16x32_bf16 v[124:127], a[44:47], v[220:223], v[124:127]
ds_read_b64_tr_b16 v[184:185], v10 offset:49152
buffer_load_dwordx4 v61, s[28:31], s17 offen offset:1024  lds
v_mfma_f32_16x16x32_bf16 v[64:67], a[48:51], v[160:163], v[64:67]
ds_read_b128 a[60:63], v25 offset:34816
ds_read_b64_tr_b16 v[186:187], v10 offset:50176
v_mfma_f32_16x16x32_bf16 v[96:99], a[52:55], v[160:163], v[96:99]
ds_read_b64_tr_b16 v[188:189], v11 offset:49152
buffer_load_dwordx4 v62, s[28:31], s17 offen offset:2048  lds
v_mfma_f32_16x16x32_bf16 v[68:71], a[48:51], v[164:167], v[68:71]
ds_read_b64_tr_b16 v[190:191], v11 offset:50176
s_waitcnt lgkmcnt(10)
v_mfma_f32_16x16x32_bf16 v[100:103], a[52:55], v[164:167], v[100:103]
ds_read_b64_tr_b16 v[192:193], v4 offset:57344
buffer_load_dwordx4 v63, s[28:31], s17 offen offset:3072  lds
v_mfma_f32_16x16x32_bf16 v[72:75], a[48:51], v[168:171], v[72:75]
ds_read_b64_tr_b16 v[194:195], v4 offset:58368
s_add_u32 m0, s100, 32768
v_mfma_f32_16x16x32_bf16 v[104:107], a[52:55], v[168:171], v[104:107]
ds_read_b64_tr_b16 v[196:197], v5 offset:57344
buffer_load_dwordx4 v56, s[24:27], s10 offen offset:0  lds
v_mfma_f32_16x16x32_bf16 v[76:79], a[48:51], v[172:175], v[76:79]
ds_read_b64_tr_b16 v[198:199], v5 offset:58368
s_waitcnt lgkmcnt(9)
v_mfma_f32_16x16x32_bf16 v[108:111], a[52:55], v[172:175], v[108:111]
ds_read_b64_tr_b16 v[200:201], v6 offset:57344
buffer_load_dwordx4 v57, s[24:27], s10 offen offset:1024  lds
v_mfma_f32_16x16x32_bf16 v[80:83], a[48:51], v[176:179], v[80:83]
ds_read_b64_tr_b16 v[202:203], v6 offset:58368
v_mfma_f32_16x16x32_bf16 v[112:115], a[52:55], v[176:179], v[112:115]
ds_read_b64_tr_b16 v[204:205], v7 offset:57344
buffer_load_dwordx4 v58, s[24:27], s10 offen offset:2048  lds
v_mfma_f32_16x16x32_bf16 v[84:87], a[48:51], v[180:183], v[84:87]
ds_read_b64_tr_b16 v[206:207], v7 offset:58368
s_waitcnt lgkmcnt(8)
v_mfma_f32_16x16x32_bf16 v[116:119], a[52:55], v[180:183], v[116:119]
ds_read_b64_tr_b16 v[208:209], v8 offset:57344
buffer_load_dwordx4 v59, s[24:27], s10 offen offset:3072  lds
v_mfma_f32_16x16x32_bf16 v[88:91], a[48:51], v[184:187], v[88:91]
ds_read_b64_tr_b16 v[210:211], v8 offset:58368
s_add_u32 m0, s100, 49152
v_mfma_f32_16x16x32_bf16 v[120:123], a[52:55], v[184:187], v[120:123]
ds_read_b64_tr_b16 v[212:213], v9 offset:57344
buffer_load_dwordx4 v60, s[28:31], s18 offen offset:0  lds
v_mfma_f32_16x16x32_bf16 v[92:95], a[48:51], v[188:191], v[92:95]
ds_read_b64_tr_b16 v[214:215], v9 offset:58368
s_waitcnt lgkmcnt(8)
v_mfma_f32_16x16x32_bf16 v[124:127], a[52:55], v[188:191], v[124:127]
ds_read_b64_tr_b16 v[216:217], v10 offset:57344
buffer_load_dwordx4 v61, s[28:31], s18 offen offset:1024  lds
v_mfma_f32_16x16x32_bf16 v[64:67], a[56:59], v[192:195], v[64:67]
ds_read_b64_tr_b16 v[218:219], v10 offset:58368
v_mfma_f32_16x16x32_bf16 v[96:99], a[60:63], v[192:195], v[96:99]
ds_read_b64_tr_b16 v[220:221], v11 offset:57344
buffer_load_dwordx4 v62, s[28:31], s18 offen offset:2048  lds
v_mfma_f32_16x16x32_bf16 v[68:71], a[56:59], v[196:199], v[68:71]
ds_read_b64_tr_b16 v[222:223], v11 offset:58368
s_waitcnt lgkmcnt(8)
v_mfma_f32_16x16x32_bf16 v[100:103], a[60:63], v[196:199], v[100:103]
s_waitcnt vmcnt(15)
s_barrier
v_add_u32 v4, 0x10000, v4
ds_read_b64_tr_b16 v[160:161], v4 offset:16384
v_mfma_f32_16x16x32_bf16 v[72:75], a[56:59], v[200:203], v[72:75]
v_add_u32 v24, 0x10000, v24
ds_read_b128 a[64:67], v24 offset:0
ds_read_b64_tr_b16 v[162:163], v4 offset:17408
v_mfma_f32_16x16x32_bf16 v[104:107], a[60:63], v[200:203], v[104:107]
v_add_u32 v5, 0x10000, v5
ds_read_b64_tr_b16 v[164:165], v5 offset:16384
v_mfma_f32_16x16x32_bf16 v[76:79], a[56:59], v[204:207], v[76:79]
ds_read_b128 a[68:71], v24 offset:2048
ds_read_b64_tr_b16 v[166:167], v5 offset:17408
s_waitcnt lgkmcnt(10)
v_mfma_f32_16x16x32_bf16 v[108:111], a[60:63], v[204:207], v[108:111]
v_add_u32 v6, 0x10000, v6
ds_read_b64_tr_b16 v[168:169], v6 offset:16384
v_mfma_f32_16x16x32_bf16 v[80:83], a[56:59], v[208:211], v[80:83]
ds_read_b64_tr_b16 v[170:171], v6 offset:17408
buffer_load_dwordx4 v63, s[28:31], s18 offen offset:3072  lds
v_mfma_f32_16x16x32_bf16 v[112:115], a[60:63], v[208:211], v[112:115]
v_add_u32 v7, 0x10000, v7
ds_read_b64_tr_b16 v[172:173], v7 offset:16384
v_mfma_f32_16x16x32_bf16 v[84:87], a[56:59], v[212:215], v[84:87]
ds_read_b64_tr_b16 v[174:175], v7 offset:17408
s_waitcnt lgkmcnt(10)
v_mfma_f32_16x16x32_bf16 v[116:119], a[60:63], v[212:215], v[116:119]
v_add_u32 v8, 0x10000, v8
ds_read_b64_tr_b16 v[176:177], v8 offset:16384
v_mfma_f32_16x16x32_bf16 v[88:91], a[56:59], v[216:219], v[88:91]
ds_read_b64_tr_b16 v[178:179], v8 offset:17408
s_add_u32 m0, s100, 65536
v_mfma_f32_16x16x32_bf16 v[120:123], a[60:63], v[216:219], v[120:123]
v_add_u32 v9, 0x10000, v9
ds_read_b64_tr_b16 v[180:181], v9 offset:16384
v_mfma_f32_16x16x32_bf16 v[92:95], a[56:59], v[220:223], v[92:95]
v_add_u32 v25, 0x10000, v25
ds_read_b128 a[72:75], v25 offset:0
ds_read_b64_tr_b16 v[182:183], v9 offset:17408
s_waitcnt lgkmcnt(9)
v_mfma_f32_16x16x32_bf16 v[124:127], a[60:63], v[220:223], v[124:127]
v_add_u32 v10, 0x10000, v10
ds_read_b64_tr_b16 v[184:185], v10 offset:16384
v_mfma_f32_16x16x32_bf16 v[64:67], a[64:67], v[160:163], v[64:67]
ds_read_b128 a[76:79], v25 offset:2048
ds_read_b64_tr_b16 v[186:187], v10 offset:17408
v_mfma_f32_16x16x32_bf16 v[96:99], a[68:71], v[160:163], v[96:99]
v_add_u32 v11, 0x10000, v11
ds_read_b64_tr_b16 v[188:189], v11 offset:16384
v_mfma_f32_16x16x32_bf16 v[68:71], a[64:67], v[164:167], v[68:71]
ds_read_b64_tr_b16 v[190:191], v11 offset:17408
s_waitcnt lgkmcnt(10)
v_mfma_f32_16x16x32_bf16 v[100:103], a[68:71], v[164:167], v[100:103]
ds_read_b64_tr_b16 v[192:193], v4 offset:24576
buffer_load_dwordx4 v56, s[24:27], s11 offen offset:0  lds
v_mfma_f32_16x16x32_bf16 v[72:75], a[64:67], v[168:171], v[72:75]
ds_read_b64_tr_b16 v[194:195], v4 offset:25600
v_mfma_f32_16x16x32_bf16 v[104:107], a[68:71], v[168:171], v[104:107]
ds_read_b64_tr_b16 v[196:197], v5 offset:24576
buffer_load_dwordx4 v57, s[24:27], s11 offen offset:1024  lds
v_mfma_f32_16x16x32_bf16 v[76:79], a[64:67], v[172:175], v[76:79]
ds_read_b64_tr_b16 v[198:199], v5 offset:25600
s_waitcnt lgkmcnt(9)
v_mfma_f32_16x16x32_bf16 v[108:111], a[68:71], v[172:175], v[108:111]
ds_read_b64_tr_b16 v[200:201], v6 offset:24576
buffer_load_dwordx4 v58, s[24:27], s11 offen offset:2048  lds
v_mfma_f32_16x16x32_bf16 v[80:83], a[64:67], v[176:179], v[80:83]
ds_read_b64_tr_b16 v[202:203], v6 offset:25600
v_mfma_f32_16x16x32_bf16 v[112:115], a[68:71], v[176:179], v[112:115]
ds_read_b64_tr_b16 v[204:205], v7 offset:24576
buffer_load_dwordx4 v59, s[24:27], s11 offen offset:3072  lds
v_mfma_f32_16x16x32_bf16 v[84:87], a[64:67], v[180:183], v[84:87]
ds_read_b64_tr_b16 v[206:207], v7 offset:25600
s_waitcnt lgkmcnt(8)
v_mfma_f32_16x16x32_bf16 v[116:119], a[68:71], v[180:183], v[116:119]
ds_read_b64_tr_b16 v[208:209], v8 offset:24576
s_add_u32 m0, s100, 81920
v_mfma_f32_16x16x32_bf16 v[88:91], a[64:67], v[184:187], v[88:91]
ds_read_b64_tr_b16 v[210:211], v8 offset:25600
buffer_load_dwordx4 v60, s[28:31], s19 offen offset:0  lds
v_mfma_f32_16x16x32_bf16 v[120:123], a[68:71], v[184:187], v[120:123]
ds_read_b64_tr_b16 v[212:213], v9 offset:24576
v_mfma_f32_16x16x32_bf16 v[92:95], a[64:67], v[188:191], v[92:95]
ds_read_b64_tr_b16 v[214:215], v9 offset:25600
s_waitcnt lgkmcnt(8)
v_mfma_f32_16x16x32_bf16 v[124:127], a[68:71], v[188:191], v[124:127]
ds_read_b64_tr_b16 v[216:217], v10 offset:24576
buffer_load_dwordx4 v61, s[28:31], s19 offen offset:1024  lds
v_mfma_f32_16x16x32_bf16 v[64:67], a[72:75], v[192:195], v[64:67]
ds_read_b64_tr_b16 v[218:219], v10 offset:25600
v_mfma_f32_16x16x32_bf16 v[96:99], a[76:79], v[192:195], v[96:99]
ds_read_b64_tr_b16 v[220:221], v11 offset:24576
buffer_load_dwordx4 v62, s[28:31], s19 offen offset:2048  lds
v_mfma_f32_16x16x32_bf16 v[68:71], a[72:75], v[196:199], v[68:71]
ds_read_b64_tr_b16 v[222:223], v11 offset:25600
s_waitcnt lgkmcnt(8)
v_mfma_f32_16x16x32_bf16 v[100:103], a[76:79], v[196:199], v[100:103]
s_waitcnt vmcnt(15)
s_barrier
v_add_u32 v4, 0xfffe0000, v4
ds_read_b64_tr_b16 v[160:161], v4 offset:16384
v_mfma_f32_16x16x32_bf16 v[72:75], a[72:75], v[200:203], v[72:75]
v_add_u32 v24, 0xfffe0000, v24
ds_read_b128 a[80:83], v24 offset:0
ds_read_b64_tr_b16 v[162:163], v4 offset:17408
v_mfma_f32_16x16x32_bf16 v[104:107], a[76:79], v[200:203], v[104:107]
v_add_u32 v5, 0xfffe0000, v5
ds_read_b64_tr_b16 v[164:165], v5 offset:16384
v_mfma_f32_16x16x32_bf16 v[76:79], a[72:75], v[204:207], v[76:79]
ds_read_b128 a[84:87], v24 offset:2048
ds_read_b64_tr_b16 v[166:167], v5 offset:17408
s_waitcnt lgkmcnt(10)
v_mfma_f32_16x16x32_bf16 v[108:111], a[76:79], v[204:207], v[108:111]
v_add_u32 v6, 0xfffe0000, v6
ds_read_b64_tr_b16 v[168:169], v6 offset:16384
v_mfma_f32_16x16x32_bf16 v[80:83], a[72:75], v[208:211], v[80:83]
ds_read_b64_tr_b16 v[170:171], v6 offset:17408
buffer_load_dwordx4 v63, s[28:31], s19 offen offset:3072  lds
v_mfma_f32_16x16x32_bf16 v[112:115], a[76:79], v[208:211], v[112:115]
v_add_u32 v7, 0xfffe0000, v7
ds_read_b64_tr_b16 v[172:173], v7 offset:16384
v_mfma_f32_16x16x32_bf16 v[84:87], a[72:75], v[212:215], v[84:87]
ds_read_b64_tr_b16 v[174:175], v7 offset:17408
s_waitcnt lgkmcnt(10)
v_mfma_f32_16x16x32_bf16 v[116:119], a[76:79], v[212:215], v[116:119]
v_add_u32 v8, 0xfffe0000, v8
ds_read_b64_tr_b16 v[176:177], v8 offset:16384
v_mfma_f32_16x16x32_bf16 v[88:91], a[72:75], v[216:219], v[88:91]
ds_read_b64_tr_b16 v[178:179], v8 offset:17408
buffer_load_dword v253, v42, s[28:31], 0 offen
v_mfma_f32_16x16x32_bf16 v[120:123], a[76:79], v[216:219], v[120:123]
v_add_u32 v9, 0xfffe0000, v9
ds_read_b64_tr_b16 v[180:181], v9 offset:16384
v_mfma_f32_16x16x32_bf16 v[92:95], a[72:75], v[220:223], v[92:95]
v_add_u32 v25, 0xfffe0000, v25
ds_read_b128 a[88:91], v25 offset:0
ds_read_b64_tr_b16 v[182:183], v9 offset:17408
s_waitcnt lgkmcnt(9)
v_mfma_f32_16x16x32_bf16 v[124:127], a[76:79], v[220:223], v[124:127]
v_add_u32 v10, 0xfffe0000, v10
ds_read_b64_tr_b16 v[184:185], v10 offset:16384
v_mfma_f32_16x16x32_bf16 v[64:67], a[80:83], v[160:163], v[64:67]
ds_read_b128 a[92:95], v25 offset:2048
ds_read_b64_tr_b16 v[186:187], v10 offset:17408
v_mfma_f32_16x16x32_bf16 v[96:99], a[84:87], v[160:163], v[96:99]
v_add_u32 v11, 0xfffe0000, v11
ds_read_b64_tr_b16 v[188:189], v11 offset:16384
v_mfma_f32_16x16x32_bf16 v[68:71], a[80:83], v[164:167], v[68:71]
ds_read_b64_tr_b16 v[190:191], v11 offset:17408
s_waitcnt lgkmcnt(10)
v_mfma_f32_16x16x32_bf16 v[100:103], a[84:87], v[164:167], v[100:103]
ds_read_b64_tr_b16 v[192:193], v4 offset:24576
v_mfma_f32_16x16x32_bf16 v[72:75], a[80:83], v[168:171], v[72:75]
ds_read_b64_tr_b16 v[194:195], v4 offset:25600
v_mfma_f32_16x16x32_bf16 v[104:107], a[84:87], v[168:171], v[104:107]
ds_read_b64_tr_b16 v[196:197], v5 offset:24576
v_mfma_f32_16x16x32_bf16 v[76:79], a[80:83], v[172:175], v[76:79]
ds_read_b64_tr_b16 v[198:199], v5 offset:25600
s_waitcnt lgkmcnt(9)
v_mfma_f32_16x16x32_bf16 v[108:111], a[84:87], v[172:175], v[108:111]
ds_read_b64_tr_b16 v[200:201], v6 offset:24576
v_mfma_f32_16x16x32_bf16 v[80:83], a[80:83], v[176:179], v[80:83]
ds_read_b64_tr_b16 v[202:203], v6 offset:25600
v_mfma_f32_16x16x32_bf16 v[112:115], a[84:87], v[176:179], v[112:115]
ds_read_b64_tr_b16 v[204:205], v7 offset:24576
v_mfma_f32_16x16x32_bf16 v[84:87], a[80:83], v[180:183], v[84:87]
ds_read_b64_tr_b16 v[206:207], v7 offset:25600
s_waitcnt lgkmcnt(8)
v_mfma_f32_16x16x32_bf16 v[116:119], a[84:87], v[180:183], v[116:119]
ds_read_b64_tr_b16 v[208:209], v8 offset:24576
v_mfma_f32_16x16x32_bf16 v[88:91], a[80:83], v[184:187], v[88:91]
ds_read_b64_tr_b16 v[210:211], v8 offset:25600
v_mfma_f32_16x16x32_bf16 v[120:123], a[84:87], v[184:187], v[120:123]
ds_read_b64_tr_b16 v[212:213], v9 offset:24576
v_mfma_f32_16x16x32_bf16 v[92:95], a[80:83], v[188:191], v[92:95]
ds_read_b64_tr_b16 v[214:215], v9 offset:25600
s_waitcnt lgkmcnt(8)
v_mfma_f32_16x16x32_bf16 v[124:127], a[84:87], v[188:191], v[124:127]
ds_read_b64_tr_b16 v[216:217], v10 offset:24576
v_mfma_f32_16x16x32_bf16 v[64:67], a[88:91], v[192:195], v[64:67]
ds_read_b64_tr_b16 v[218:219], v10 offset:25600
v_mfma_f32_16x16x32_bf16 v[96:99], a[92:95], v[192:195], v[96:99]
ds_read_b64_tr_b16 v[220:221], v11 offset:24576
v_mfma_f32_16x16x32_bf16 v[68:71], a[88:91], v[196:199], v[68:71]
ds_read_b64_tr_b16 v[222:223], v11 offset:25600
s_waitcnt lgkmcnt(8)
v_mfma_f32_16x16x32_bf16 v[100:103], a[92:95], v[196:199], v[100:103]
s_waitcnt vmcnt(9)
s_barrier
ds_read_b64_tr_b16 v[160:161], v4 offset:49152
v_mfma_f32_16x16x32_bf16 v[72:75], a[88:91], v[200:203], v[72:75]
ds_read_b128 a[96:99], v24 offset:32768
ds_read_b64_tr_b16 v[162:163], v4 offset:50176
v_mfma_f32_16x16x32_bf16 v[104:107], a[92:95], v[200:203], v[104:107]
ds_read_b64_tr_b16 v[164:165], v5 offset:49152
v_mfma_f32_16x16x32_bf16 v[76:79], a[88:91], v[204:207], v[76:79]
ds_read_b128 a[100:103], v24 offset:34816
ds_read_b64_tr_b16 v[166:167], v5 offset:50176
s_waitcnt lgkmcnt(10)
v_mfma_f32_16x16x32_bf16 v[108:111], a[92:95], v[204:207], v[108:111]
ds_read_b64_tr_b16 v[168:169], v6 offset:49152
v_mfma_f32_16x16x32_bf16 v[80:83], a[88:91], v[208:211], v[80:83]
ds_read_b64_tr_b16 v[170:171], v6 offset:50176
v_mfma_f32_16x16x32_bf16 v[112:115], a[92:95], v[208:211], v[112:115]
ds_read_b64_tr_b16 v[172:173], v7 offset:49152
v_mfma_f32_16x16x32_bf16 v[84:87], a[88:91], v[212:215], v[84:87]
ds_read_b64_tr_b16 v[174:175], v7 offset:50176
s_waitcnt lgkmcnt(10)
v_mfma_f32_16x16x32_bf16 v[116:119], a[92:95], v[212:215], v[116:119]
ds_read_b64_tr_b16 v[176:177], v8 offset:49152
v_mfma_f32_16x16x32_bf16 v[88:91], a[88:91], v[216:219], v[88:91]
ds_read_b64_tr_b16 v[178:179], v8 offset:50176
v_mfma_f32_16x16x32_bf16 v[120:123], a[92:95], v[216:219], v[120:123]
ds_read_b64_tr_b16 v[180:181], v9 offset:49152
v_mfma_f32_16x16x32_bf16 v[92:95], a[88:91], v[220:223], v[92:95]
ds_read_b128 a[104:107], v25 offset:32768
ds_read_b64_tr_b16 v[182:183], v9 offset:50176
s_waitcnt lgkmcnt(9)
v_mfma_f32_16x16x32_bf16 v[124:127], a[92:95], v[220:223], v[124:127]
ds_read_b64_tr_b16 v[184:185], v10 offset:49152
v_mfma_f32_16x16x32_bf16 v[64:67], a[96:99], v[160:163], v[64:67]
ds_read_b128 a[108:111], v25 offset:34816
ds_read_b64_tr_b16 v[186:187], v10 offset:50176
v_mfma_f32_16x16x32_bf16 v[96:99], a[100:103], v[160:163], v[96:99]
ds_read_b64_tr_b16 v[188:189], v11 offset:49152
v_mfma_f32_16x16x32_bf16 v[68:71], a[96:99], v[164:167], v[68:71]
ds_read_b64_tr_b16 v[190:191], v11 offset:50176
s_waitcnt lgkmcnt(10)
v_mfma_f32_16x16x32_bf16 v[100:103], a[100:103], v[164:167], v[100:103]
ds_read_b64_tr_b16 v[192:193], v4 offset:57344
v_mfma_f32_16x16x32_bf16 v[72:75], a[96:99], v[168:171], v[72:75]
ds_read_b64_tr_b16 v[194:195], v4 offset:58368
v_mfma_f32_16x16x32_bf16 v[104:107], a[100:103], v[168:171], v[104:107]
ds_read_b64_tr_b16 v[196:197], v5 offset:57344
v_mfma_f32_16x16x32_bf16 v[76:79], a[96:99], v[172:175], v[76:79]
ds_read_b64_tr_b16 v[198:199], v5 offset:58368
s_waitcnt lgkmcnt(9)
v_mfma_f32_16x16x32_bf16 v[108:111], a[100:103], v[172:175], v[108:111]
ds_read_b64_tr_b16 v[200:201], v6 offset:57344
s_add_u32 m0, s22, 98304
v_mfma_f32_16x16x32_bf16 v[80:83], a[96:99], v[176:179], v[80:83]
ds_read_b64_tr_b16 v[202:203], v6 offset:58368
buffer_load_dwordx4 v26, s[28:31], s12 offen offset:0  lds
v_mfma_f32_16x16x32_bf16 v[112:115], a[100:103], v[176:179], v[112:115]
ds_read_b64_tr_b16 v[204:205], v7 offset:57344
v_mfma_f32_16x16x32_bf16 v[84:87], a[96:99], v[180:183], v[84:87]
ds_read_b64_tr_b16 v[206:207], v7 offset:58368
s_waitcnt lgkmcnt(8)
v_mfma_f32_16x16x32_bf16 v[116:119], a[100:103], v[180:183], v[116:119]
ds_read_b64_tr_b16 v[208:209], v8 offset:57344
buffer_load_dwordx4 v27, s[28:31], s12 offen offset:1024  lds
v_mfma_f32_16x16x32_bf16 v[88:91], a[96:99], v[184:187], v[88:91]
ds_read_b64_tr_b16 v[210:211], v8 offset:58368
v_mfma_f32_16x16x32_bf16 v[120:123], a[100:103], v[184:187], v[120:123]
ds_read_b64_tr_b16 v[212:213], v9 offset:57344
s_add_u32 m0, s22, 106496
v_mfma_f32_16x16x32_bf16 v[92:95], a[96:99], v[188:191], v[92:95]
ds_read_b64_tr_b16 v[214:215], v9 offset:58368
s_waitcnt lgkmcnt(8)
v_mfma_f32_16x16x32_bf16 v[124:127], a[100:103], v[188:191], v[124:127]
ds_read_b64_tr_b16 v[216:217], v10 offset:57344
buffer_load_dwordx4 v26, s[28:31], s13 offen offset:0  lds
v_mfma_f32_16x16x32_bf16 v[64:67], a[104:107], v[192:195], v[64:67]
ds_read_b64_tr_b16 v[218:219], v10 offset:58368
v_mfma_f32_16x16x32_bf16 v[96:99], a[108:111], v[192:195], v[96:99]
ds_read_b64_tr_b16 v[220:221], v11 offset:57344
buffer_load_dwordx4 v27, s[28:31], s13 offen offset:1024  lds
v_mfma_f32_16x16x32_bf16 v[68:71], a[104:107], v[196:199], v[68:71]
ds_read_b64_tr_b16 v[222:223], v11 offset:58368
s_waitcnt lgkmcnt(8)
v_mfma_f32_16x16x32_bf16 v[100:103], a[108:111], v[196:199], v[100:103]
s_waitcnt vmcnt(5)
s_barrier
v_add_u32 v4, 0x10000, v4
ds_read_b64_tr_b16 v[160:161], v4 offset:16384
v_mfma_f32_16x16x32_bf16 v[72:75], a[104:107], v[200:203], v[72:75]
v_add_u32 v24, 0x10000, v24
ds_read_b128 a[112:115], v24 offset:0
ds_read_b64_tr_b16 v[162:163], v4 offset:17408
v_mfma_f32_16x16x32_bf16 v[104:107], a[108:111], v[200:203], v[104:107]
v_add_u32 v5, 0x10000, v5
ds_read_b64_tr_b16 v[164:165], v5 offset:16384
v_mfma_f32_16x16x32_bf16 v[76:79], a[104:107], v[204:207], v[76:79]
ds_read_b128 a[116:119], v24 offset:2048
ds_read_b64_tr_b16 v[166:167], v5 offset:17408
s_waitcnt lgkmcnt(10)
v_mfma_f32_16x16x32_bf16 v[108:111], a[108:111], v[204:207], v[108:111]
v_add_u32 v6, 0x10000, v6
ds_read_b64_tr_b16 v[168:169], v6 offset:16384
v_mfma_f32_16x16x32_bf16 v[80:83], a[104:107], v[208:211], v[80:83]
ds_read_b64_tr_b16 v[170:171], v6 offset:17408
s_add_u32 m0, s22, 114688
v_mfma_f32_16x16x32_bf16 v[112:115], a[108:111], v[208:211], v[112:115]
v_add_u32 v7, 0x10000, v7
ds_read_b64_tr_b16 v[172:173], v7 offset:16384
v_mfma_f32_16x16x32_bf16 v[84:87], a[104:107], v[212:215], v[84:87]
ds_read_b64_tr_b16 v[174:175], v7 offset:17408
s_waitcnt lgkmcnt(10)
v_mfma_f32_16x16x32_bf16 v[116:119], a[108:111], v[212:215], v[116:119]
v_add_u32 v8, 0x10000, v8
ds_read_b64_tr_b16 v[176:177], v8 offset:16384
v_mfma_f32_16x16x32_bf16 v[88:91], a[104:107], v[216:219], v[88:91]
ds_read_b64_tr_b16 v[178:179], v8 offset:17408
buffer_load_dwordx4 v26, s[28:31], s14 offen offset:0  lds
v_mfma_f32_16x16x32_bf16 v[120:123], a[108:111], v[216:219], v[120:123]
v_add_u32 v9, 0x10000, v9
ds_read_b64_tr_b16 v[180:181], v9 offset:16384
v_mfma_f32_16x16x32_bf16 v[92:95], a[104:107], v[220:223], v[92:95]
v_add_u32 v25, 0x10000, v25
ds_read_b128 a[120:123], v25 offset:0
ds_read_b64_tr_b16 v[182:183], v9 offset:17408
s_waitcnt lgkmcnt(9)
v_mfma_f32_16x16x32_bf16 v[124:127], a[108:111], v[220:223], v[124:127]
v_add_u32 v10, 0x10000, v10
ds_read_b64_tr_b16 v[184:185], v10 offset:16384
v_mfma_f32_16x16x32_bf16 v[64:67], a[112:115], v[160:163], v[64:67]
ds_read_b128 a[124:127], v25 offset:2048
ds_read_b64_tr_b16 v[186:187], v10 offset:17408
v_mfma_f32_16x16x32_bf16 v[96:99], a[116:119], v[160:163], v[96:99]
v_add_u32 v11, 0x10000, v11
ds_read_b64_tr_b16 v[188:189], v11 offset:16384
v_mfma_f32_16x16x32_bf16 v[68:71], a[112:115], v[164:167], v[68:71]
ds_read_b64_tr_b16 v[190:191], v11 offset:17408
s_waitcnt lgkmcnt(10)
v_mfma_f32_16x16x32_bf16 v[100:103], a[116:119], v[164:167], v[100:103]
ds_read_b64_tr_b16 v[192:193], v4 offset:24576
buffer_load_dwordx4 v27, s[28:31], s14 offen offset:1024  lds
v_mfma_f32_16x16x32_bf16 v[72:75], a[112:115], v[168:171], v[72:75]
ds_read_b64_tr_b16 v[194:195], v4 offset:25600
s_add_u32 m0, s22, 122880
v_mfma_f32_16x16x32_bf16 v[104:107], a[116:119], v[168:171], v[104:107]
ds_read_b64_tr_b16 v[196:197], v5 offset:24576
buffer_load_dwordx4 v26, s[28:31], s15 offen offset:0  lds
v_mfma_f32_16x16x32_bf16 v[76:79], a[112:115], v[172:175], v[76:79]
ds_read_b64_tr_b16 v[198:199], v5 offset:25600
s_waitcnt lgkmcnt(9)
v_mfma_f32_16x16x32_bf16 v[108:111], a[116:119], v[172:175], v[108:111]
ds_read_b64_tr_b16 v[200:201], v6 offset:24576
buffer_load_dwordx4 v27, s[28:31], s15 offen offset:1024  lds
v_mfma_f32_16x16x32_bf16 v[80:83], a[112:115], v[176:179], v[80:83]
ds_read_b64_tr_b16 v[202:203], v6 offset:25600
s_add_u32 m0, s22, 131072
v_mfma_f32_16x16x32_bf16 v[112:115], a[116:119], v[176:179], v[112:115]
ds_read_b64_tr_b16 v[204:205], v7 offset:24576
buffer_load_dwordx4 v26, s[28:31], s16 offen offset:0  lds
v_mfma_f32_16x16x32_bf16 v[84:87], a[112:115], v[180:183], v[84:87]
ds_read_b64_tr_b16 v[206:207], v7 offset:25600
s_waitcnt lgkmcnt(8)
v_mfma_f32_16x16x32_bf16 v[116:119], a[116:119], v[180:183], v[116:119]
ds_read_b64_tr_b16 v[208:209], v8 offset:24576
buffer_load_dwordx4 v27, s[28:31], s16 offen offset:1024  lds
v_mfma_f32_16x16x32_bf16 v[88:91], a[112:115], v[184:187], v[88:91]
ds_read_b64_tr_b16 v[210:211], v8 offset:25600
s_add_u32 m0, s22, 139264
v_mfma_f32_16x16x32_bf16 v[120:123], a[116:119], v[184:187], v[120:123]
ds_read_b64_tr_b16 v[212:213], v9 offset:24576
buffer_load_dwordx4 v26, s[28:31], s17 offen offset:0  lds
v_mfma_f32_16x16x32_bf16 v[92:95], a[112:115], v[188:191], v[92:95]
ds_read_b64_tr_b16 v[214:215], v9 offset:25600
s_waitcnt lgkmcnt(8)
v_mfma_f32_16x16x32_bf16 v[124:127], a[116:119], v[188:191], v[124:127]
ds_read_b64_tr_b16 v[216:217], v10 offset:24576
buffer_load_dwordx4 v27, s[28:31], s17 offen offset:1024  lds
v_mfma_f32_16x16x32_bf16 v[64:67], a[120:123], v[192:195], v[64:67]
ds_read_b64_tr_b16 v[218:219], v10 offset:25600
s_add_u32 m0, s22, 147456
v_mfma_f32_16x16x32_bf16 v[96:99], a[124:127], v[192:195], v[96:99]
ds_read_b64_tr_b16 v[220:221], v11 offset:24576
buffer_load_dwordx4 v26, s[28:31], s18 offen offset:0  lds
v_mfma_f32_16x16x32_bf16 v[68:71], a[120:123], v[196:199], v[68:71]
ds_read_b64_tr_b16 v[222:223], v11 offset:25600
s_waitcnt lgkmcnt(8)
v_mfma_f32_16x16x32_bf16 v[100:103], a[124:127], v[196:199], v[100:103]
s_waitcnt vmcnt(62)
buffer_load_dwordx4 v27, s[28:31], s18 offen offset:1024  lds
v_mfma_f32_16x16x32_bf16 v[72:75], a[120:123], v[200:203], v[72:75]
v_readfirstlane_b32 s53, v30
s_add_u32 m0, s22, 155648
v_mfma_f32_16x16x32_bf16 v[104:107], a[124:127], v[200:203], v[104:107]
buffer_load_dwordx4 v26, s[28:31], s19 offen offset:0  lds
v_mfma_f32_16x16x32_bf16 v[76:79], a[120:123], v[204:207], v[76:79]
s_waitcnt lgkmcnt(4)
s_add_u32 s53, s53, 0x9e3779b1
v_mfma_f32_16x16x32_bf16 v[108:111], a[124:127], v[204:207], v[108:111]
v_mov_b32 v48, s53
buffer_load_dwordx4 v27, s[28:31], s19 offen offset:1024  lds
v_mfma_f32_16x16x32_bf16 v[80:83], a[120:123], v[208:211], v[80:83]
s_andn2_b32 s51, s53, 15
v_mfma_f32_16x16x32_bf16 v[112:115], a[124:127], v[208:211], v[112:115]
s_or_b32 s51, s51, s95
v_mfma_f32_16x16x32_bf16 v[84:87], a[120:123], v[212:215], v[84:87]
s_waitcnt lgkmcnt(0)
v_mov_b32 v244, s51
v_mfma_f32_16x16x32_bf16 v[116:119], a[124:127], v[212:215], v[116:119]
v_mov_b32 v57, v43
v_mfma_f32_16x16x32_bf16 v[88:91], a[120:123], v[216:219], v[88:91]
v_mfma_f32_16x16x32_bf16 v[120:123], a[124:127], v[216:219], v[120:123]
v_mfma_f32_16x16x32_bf16 v[92:95], a[120:123], v[220:223], v[92:95]
v_mfma_f32_16x16x32_bf16 v[124:127], a[124:127], v[220:223], v[124:127]
v_pk_mul_f32 v[32:33], v[64:65], s[56:57]
v_pk_add_f32 v[34:35], v[64:65], s[58:59]
v_exp_f32 v32, v32 clamp
v_exp_f32 v33, v33 clamp
buffer_load_dword v253, v57, s[32:35], 0 offen
v_pk_mul_f32 v[36:37], v[66:67], s[56:57]
v_pk_add_f32 v[38:39], v[66:67], s[58:59]
v_exp_f32 v36, v36 clamp
v_exp_f32 v37, v37 clamp
v_pk_add_f32 v[32:33], v[32:33], s[60:61]
v_max_f32 v34, v34, v32
v_max_f32 v35, v35, v33
v_cvt_pk_bf16_f32 v224, v34, v35
v_pk_mul_f32 v[40:41], v[96:97], s[56:57]
v_pk_add_f32 v[42:43], v[96:97], s[58:59]
v_exp_f32 v40, v40 clamp
v_exp_f32 v41, v41 clamp
v_pk_add_f32 v[36:37], v[36:37], s[60:61]
v_max_f32 v38, v38, v36
v_max_f32 v39, v39, v37
v_cvt_pk_bf16_f32 v225, v38, v39
v_cvt_pk_bf16_f32 v160, v80, v81
v_cvt_pk_bf16_f32 v161, v82, v83
v_cvt_pk_bf16_f32 v162, v112, v113
v_cvt_pk_bf16_f32 v163, v114, v115
v_pk_mul_f32 v[32:33], v[98:99], s[56:57]
v_pk_add_f32 v[34:35], v[98:99], s[58:59]
v_exp_f32 v32, v32 clamp
v_exp_f32 v33, v33 clamp
v_pk_add_f32 v[40:41], v[40:41], s[60:61]
v_max_f32 v42, v42, v40
v_max_f32 v43, v43, v41
v_cvt_pk_bf16_f32 v226, v42, v43
v_pk_mul_f32 v[36:37], v[68:69], s[56:57]
v_pk_add_f32 v[38:39], v[68:69], s[58:59]
v_exp_f32 v36, v36 clamp
v_exp_f32 v37, v37 clamp
v_pk_add_f32 v[32:33], v[32:33], s[60:61]
v_max_f32 v34, v34, v32
v_max_f32 v35, v35, v33
v_cvt_pk_bf16_f32 v227, v34, v35
v_pk_mul_f32 v[40:41], v[70:71], s[56:57]
v_pk_add_f32 v[42:43], v[70:71], s[58:59]
v_exp_f32 v40, v40 clamp
v_exp_f32 v41, v41 clamp
v_pk_add_f32 v[36:37], v[36:37], s[60:61]
v_max_f32 v38, v38, v36
v_max_f32 v39, v39, v37
v_cvt_pk_bf16_f32 v228, v38, v39
v_mfma_f32_16x16x32_bf16 v[180:183], v[224:227], v[160:163], 0
v_mfma_f32_16x16x32_bf16 v[196:199], v[224:227], a[128:131], 0
v_pk_mul_f32 v[32:33], v[100:101], s[56:57]
v_pk_add_f32 v[34:35], v[100:101], s[58:59]
v_exp_f32 v32, v32 clamp
v_exp_f32 v33, v33 clamp
v_pk_add_f32 v[40:41], v[40:41], s[60:61]
v_max_f32 v42, v42, v40
v_max_f32 v43, v43, v41
v_cvt_pk_bf16_f32 v229, v42, v43
v_cvt_pk_bf16_f32 v164, v84, v85
v_cvt_pk_bf16_f32 v165, v86, v87
v_cvt_pk_bf16_f32 v166, v116, v117
v_cvt_pk_bf16_f32 v167, v118, v119
v_pk_mul_f32 v[36:37], v[102:103], s[56:57]
v_pk_add_f32 v[38:39], v[102:103], s[58:59]
v_exp_f32 v36, v36 clamp
v_exp_f32 v37, v37 clamp
v_pk_add_f32 v[32:33], v[32:33], s[60:61]
v_max_f32 v34, v34, v32
v_max_f32 v35, v35, v33
v_cvt_pk_bf16_f32 v230, v34, v35
ds_write_b128 v245, v[180:183] offset:0
s_mov_b64 exec, s[90:91]
ds_write_b128 v246, v[196:199] offset:0
s_mov_b64 exec, -1
v_pk_mul_f32 v[40:41], v[72:73], s[56:57]
v_pk_add_f32 v[42:43], v[72:73], s[58:59]
v_exp_f32 v40, v40 clamp
v_exp_f32 v41, v41 clamp
v_pk_add_f32 v[36:37], v[36:37], s[60:61]
v_max_f32 v38, v38, v36
v_max_f32 v39, v39, v37
v_cvt_pk_bf16_f32 v231, v38, v39
v_pk_mul_f32 v[32:33], v[74:75], s[56:57]
v_pk_add_f32 v[34:35], v[74:75], s[58:59]
v_exp_f32 v32, v32 clamp
v_exp_f32 v33, v33 clamp
v_pk_add_f32 v[40:41], v[40:41], s[60:61]
v_max_f32 v42, v42, v40
v_max_f32 v43, v43, v41
v_cvt_pk_bf16_f32 v232, v42, v43
v_mfma_f32_16x16x32_bf16 v[184:187], v[228:231], v[164:167], 0
v_mfma_f32_16x16x32_bf16 v[200:203], v[228:231], a[128:131], 0
v_pk_mul_f32 v[36:37], v[104:105], s[56:57]
v_pk_add_f32 v[38:39], v[104:105], s[58:59]
v_exp_f32 v36, v36 clamp
v_exp_f32 v37, v37 clamp
v_pk_add_f32 v[32:33], v[32:33], s[60:61]
v_max_f32 v34, v34, v32
v_max_f32 v35, v35, v33
v_cvt_pk_bf16_f32 v233, v34, v35
v_cvt_pk_bf16_f32 v168, v88, v89
v_cvt_pk_bf16_f32 v169, v90, v91
v_cvt_pk_bf16_f32 v170, v120, v121
v_cvt_pk_bf16_f32 v171, v122, v123
v_pk_mul_f32 v[40:41], v[106:107], s[56:57]
v_pk_add_f32 v[42:43], v[106:107], s[58:59]
v_exp_f32 v40, v40 clamp
v_exp_f32 v41, v41 clamp
v_pk_add_f32 v[36:37], v[36:37], s[60:61]
v_max_f32 v38, v38, v36
v_max_f32 v39, v39, v37
v_cvt_pk_bf16_f32 v234, v38, v39
ds_write_b128 v245, v[184:187] offset:1024
s_mov_b64 exec, s[90:91]
ds_write_b128 v246, v[200:203] offset:64
s_mov_b64 exec, -1
v_pk_mul_f32 v[32:33], v[76:77], s[56:57]
v_pk_add_f32 v[34:35], v[76:77], s[58:59]
v_exp_f32 v32, v32 clamp
v_exp_f32 v33, v33 clamp
v_pk_add_f32 v[40:41], v[40:41], s[60:61]
v_max_f32 v42, v42, v40
v_max_f32 v43, v43, v41
v_cvt_pk_bf16_f32 v235, v42, v43
v_pk_mul_f32 v[36:37], v[78:79], s[56:57]
v_pk_add_f32 v[38:39], v[78:79], s[58:59]
v_exp_f32 v36, v36 clamp
v_exp_f32 v37, v37 clamp
v_pk_add_f32 v[32:33], v[32:33], s[60:61]
v_max_f32 v34, v34, v32
v_max_f32 v35, v35, v33
v_cvt_pk_bf16_f32 v236, v34, v35
v_mfma_f32_16x16x32_bf16 v[188:191], v[232:235], v[168:171], 0
v_mfma_f32_16x16x32_bf16 v[204:207], v[232:235], a[128:131], 0
v_pk_mul_f32 v[40:41], v[108:109], s[56:57]
v_pk_add_f32 v[42:43], v[108:109], s[58:59]
v_exp_f32 v40, v40 clamp
v_exp_f32 v41, v41 clamp
v_pk_add_f32 v[36:37], v[36:37], s[60:61]
v_max_f32 v38, v38, v36
v_max_f32 v39, v39, v37
v_cvt_pk_bf16_f32 v237, v38, v39
v_cvt_pk_bf16_f32 v172, v92, v93
v_cvt_pk_bf16_f32 v173, v94, v95
v_cvt_pk_bf16_f32 v174, v124, v125
v_cvt_pk_bf16_f32 v175, v126, v127
v_pk_mul_f32 v[32:33], v[110:111], s[56:57]
v_pk_add_f32 v[34:35], v[110:111], s[58:59]
v_exp_f32 v32, v32 clamp
v_exp_f32 v33, v33 clamp
v_pk_add_f32 v[40:41], v[40:41], s[60:61]
v_max_f32 v42, v42, v40
v_max_f32 v43, v43, v41
v_cvt_pk_bf16_f32 v238, v42, v43
ds_write_b128 v245, v[188:191] offset:2048
s_mov_b64 exec, s[90:91]
ds_write_b128 v246, v[204:207] offset:128
s_mov_b64 exec, -1
s_nop 0
v_pk_add_f32 v[32:33], v[32:33], s[60:61]
v_max_f32 v34, v34, v32
v_max_f32 v35, v35, v33
v_cvt_pk_bf16_f32 v239, v34, v35
s_nop 1
v_mfma_f32_16x16x32_bf16 v[192:195], v[236:239], v[172:175], 0
v_mfma_f32_16x16x32_bf16 v[208:211], v[236:239], a[128:131], 0
s_nop 7
ds_write_b128 v245, v[192:195] offset:3072
s_mov_b64 exec, s[90:91]
ds_write_b128 v246, v[208:211] offset:192
s_mov_b64 exec, -1
s_waitcnt vmcnt(9)
s_waitcnt lgkmcnt(0)
s_barrier
ds_read_b128 v[160:163], v247 offset:0
ds_read_b128 v[164:167], v247 offset:4096
ds_read_b128 v[168:171], v247 offset:8192
ds_read_b128 v[172:175], v247 offset:12288
ds_read_b128 v[176:179], v248 offset:0
ds_read_b128 v[180:183], v248 offset:256
ds_read_b128 v[184:187], v248 offset:512
ds_read_b128 v[188:191], v248 offset:768
ds_read_b64_tr_b16 v[192:193], v12 offset:0
ds_read_b64_tr_b16 v[194:195], v12 offset:512
ds_read_b64_tr_b16 v[196:197], v13 offset:0
ds_read_b64_tr_b16 v[198:199], v13 offset:512
ds_read_b64_tr_b16 v[200:201], v14 offset:0
ds_read_b64_tr_b16 v[202:203], v14 offset:512
s_waitcnt lgkmcnt(12)
v_pk_add_f32 v[160:161], v[160:161], v[164:165]
v_pk_add_f32 v[162:163], v[162:163], v[166:167]
s_waitcnt lgkmcnt(10)
v_pk_add_f32 v[168:169], v[168:169], v[172:173]
v_pk_add_f32 v[170:171], v[170:171], v[174:175]
v_pk_add_f32 v[160:161], v[160:161], v[168:169]
v_pk_add_f32 v[162:163], v[162:163], v[170:171]
v_bfi_b32 v160, v49, v48, v160
v_bfi_b32 v161, v49, v48, v161
v_bfi_b32 v162, v49, v48, v162
v_bfi_b32 v163, v49, v48, v163
buffer_store_dwordx4 v[160:163], v250, s[40:43], 0 offen sc1
s_waitcnt lgkmcnt(6)
v_pk_add_f32 v[176:177], v[176:177], v[180:181]
v_pk_add_f32 v[178:179], v[178:179], v[182:183]
v_pk_add_f32 v[184:185], v[184:185], v[188:189]
v_pk_add_f32 v[186:187], v[186:187], v[190:191]
v_pk_add_f32 v[176:177], v[176:177], v[184:185]
v_pk_add_f32 v[178:179], v[178:179], v[186:187]
v_bfi_b32 v176, v49, v48, v176
v_bfi_b32 v177, v49, v48, v177
v_bfi_b32 v178, v49, v48, v178
v_bfi_b32 v179, v49, v48, v179
s_mov_b64 exec, s[90:91]
buffer_store_dwordx4 v[176:179], v249, s[40:43], 0 offen sc1
s_mov_b64 exec, 1
buffer_store_dword v244, v254, s[40:43], s94 offen sc1
s_mov_b64 exec, -1
ds_read_b64_tr_b16 v[204:205], v15 offset:0
ds_read_b64_tr_b16 v[206:207], v15 offset:512
ds_read_b64_tr_b16 v[208:209], v12 offset:4096
ds_read_b64_tr_b16 v[210:211], v12 offset:4608
ds_read_b64_tr_b16 v[212:213], v13 offset:4096
ds_read_b64_tr_b16 v[214:215], v13 offset:4608
s_waitcnt lgkmcnt(8)
ds_read_b64_tr_b16 v[216:217], v14 offset:4096
v_mov_b32 v60, 0x358637bd
v_mfma_f32_16x16x32_bf16 v[128:131], v[192:195], a[0:3], 0
ds_read_b64_tr_b16 v[218:219], v14 offset:4608
s_mov_b32 exec_hi, 3
buffer_load_dword v253, v159, s[40:43], 0 offen
s_mov_b32 exec_hi, -1
v_mfma_f32_16x16x32_bf16 v[144:147], v[192:195], a[4:7], 0
ds_read_b64_tr_b16 v[220:221], v15 offset:4096
v_mov_b32 v61, 0x358637bd
v_mfma_f32_16x16x32_bf16 v[132:135], v[196:199], a[0:3], 0
ds_read_b64_tr_b16 v[222:223], v15 offset:4608
s_waitcnt lgkmcnt(8)
v_mfma_f32_16x16x32_bf16 v[148:151], v[196:199], a[4:7], 0
ds_read_b64_tr_b16 v[192:193], v12 offset:8192
v_mov_b32 v62, 0x358637bd
v_mfma_f32_16x16x32_bf16 v[136:139], v[200:203], a[0:3], 0
ds_read_b64_tr_b16 v[194:195], v12 offset:8704
v_mov_b32 v63, 0x358637bd
v_mfma_f32_16x16x32_bf16 v[152:155], v[200:203], a[4:7], 0
ds_read_b64_tr_b16 v[196:197], v13 offset:8192
v_mfma_f32_16x16x32_bf16 v[140:143], v[204:207], a[0:3], 0
ds_read_b64_tr_b16 v[198:199], v13 offset:8704
s_waitcnt lgkmcnt(8)
v_mfma_f32_16x16x32_bf16 v[156:159], v[204:207], a[4:7], 0
ds_read_b64_tr_b16 v[200:201], v14 offset:8192
v_mfma_f32_16x16x32_bf16 v[128:131], v[208:211], a[8:11], v[128:131]
ds_read_b64_tr_b16 v[202:203], v14 offset:8704
v_mfma_f32_16x16x32_bf16 v[144:147], v[208:211], a[12:15], v[144:147]
ds_read_b64_tr_b16 v[204:205], v15 offset:8192
v_mfma_f32_16x16x32_bf16 v[132:135], v[212:215], a[8:11], v[132:135]
ds_read_b64_tr_b16 v[206:207], v15 offset:8704
s_waitcnt lgkmcnt(8)
v_mfma_f32_16x16x32_bf16 v[148:151], v[212:215], a[12:15], v[148:151]
ds_read_b64_tr_b16 v[208:209], v12 offset:12288
v_mfma_f32_16x16x32_bf16 v[136:139], v[216:219], a[8:11], v[136:139]
ds_read_b64_tr_b16 v[210:211], v12 offset:12800
v_mfma_f32_16x16x32_bf16 v[152:155], v[216:219], a[12:15], v[152:155]
ds_read_b64_tr_b16 v[212:213], v13 offset:12288
v_mfma_f32_16x16x32_bf16 v[140:143], v[220:223], a[8:11], v[140:143]
ds_read_b64_tr_b16 v[214:215], v13 offset:12800
s_waitcnt lgkmcnt(8)
v_mfma_f32_16x16x32_bf16 v[156:159], v[220:223], a[12:15], v[156:159]
ds_read_b64_tr_b16 v[216:217], v14 offset:12288
v_mfma_f32_16x16x32_bf16 v[128:131], v[192:195], a[16:19], v[128:131]
ds_read_b64_tr_b16 v[218:219], v14 offset:12800
v_mfma_f32_16x16x32_bf16 v[144:147], v[192:195], a[20:23], v[144:147]
ds_read_b64_tr_b16 v[220:221], v15 offset:12288
v_mfma_f32_16x16x32_bf16 v[132:135], v[196:199], a[16:19], v[132:135]
ds_read_b64_tr_b16 v[222:223], v15 offset:12800
s_waitcnt lgkmcnt(8)
v_mfma_f32_16x16x32_bf16 v[148:151], v[196:199], a[20:23], v[148:151]
ds_read_b64_tr_b16 v[192:193], v12 offset:16384
v_mfma_f32_16x16x32_bf16 v[136:139], v[200:203], a[16:19], v[136:139]
ds_read_b64_tr_b16 v[194:195], v12 offset:16896
v_mfma_f32_16x16x32_bf16 v[152:155], v[200:203], a[20:23], v[152:155]
ds_read_b64_tr_b16 v[196:197], v13 offset:16384
v_mfma_f32_16x16x32_bf16 v[140:143], v[204:207], a[16:19], v[140:143]
ds_read_b64_tr_b16 v[198:199], v13 offset:16896
s_waitcnt lgkmcnt(8)
v_mfma_f32_16x16x32_bf16 v[156:159], v[204:207], a[20:23], v[156:159]
ds_read_b64_tr_b16 v[200:201], v14 offset:16384
v_mfma_f32_16x16x32_bf16 v[128:131], v[208:211], a[24:27], v[128:131]
ds_read_b64_tr_b16 v[202:203], v14 offset:16896
v_mfma_f32_16x16x32_bf16 v[144:147], v[208:211], a[28:31], v[144:147]
ds_read_b64_tr_b16 v[204:205], v15 offset:16384
v_mfma_f32_16x16x32_bf16 v[132:135], v[212:215], a[24:27], v[132:135]
ds_read_b64_tr_b16 v[206:207], v15 offset:16896
s_waitcnt lgkmcnt(8)
v_mfma_f32_16x16x32_bf16 v[148:151], v[212:215], a[28:31], v[148:151]
ds_read_b64_tr_b16 v[208:209], v12 offset:20480
v_mfma_f32_16x16x32_bf16 v[136:139], v[216:219], a[24:27], v[136:139]
ds_read_b64_tr_b16 v[210:211], v12 offset:20992
v_mfma_f32_16x16x32_bf16 v[152:155], v[216:219], a[28:31], v[152:155]
ds_read_b64_tr_b16 v[212:213], v13 offset:20480
s_add_u32 s48, s46, 0
v_mfma_f32_16x16x32_bf16 v[140:143], v[220:223], a[24:27], v[140:143]
ds_read_b64_tr_b16 v[214:215], v13 offset:20992
s_waitcnt lgkmcnt(8)
v_mfma_f32_16x16x32_bf16 v[156:159], v[220:223], a[28:31], v[156:159]
ds_read_b64_tr_b16 v[216:217], v14 offset:20480
s_and_b32 s48, s48, 7
v_mfma_f32_16x16x32_bf16 v[128:131], v[192:195], a[32:35], v[128:131]
ds_read_b64_tr_b16 v[218:219], v14 offset:20992
s_lshl_b32 s63, s48, 16
v_mfma_f32_16x16x32_bf16 v[144:147], v[192:195], a[36:39], v[144:147]
ds_read_b64_tr_b16 v[220:221], v15 offset:20480
s_add_u32 m0, s22, 32768
v_mfma_f32_16x16x32_bf16 v[132:135], v[196:199], a[32:35], v[132:135]
ds_read_b64_tr_b16 v[222:223], v15 offset:20992
s_waitcnt lgkmcnt(8)
v_mfma_f32_16x16x32_bf16 v[148:151], v[196:199], a[36:39], v[148:151]
ds_read_b64_tr_b16 v[192:193], v12 offset:24576
buffer_load_dwordx4 v28, s[32:35], s63 offen offset:0  lds
v_mfma_f32_16x16x32_bf16 v[136:139], v[200:203], a[32:35], v[136:139]
ds_read_b64_tr_b16 v[194:195], v12 offset:25088
v_mfma_f32_16x16x32_bf16 v[152:155], v[200:203], a[36:39], v[152:155]
ds_read_b64_tr_b16 v[196:197], v13 offset:24576
buffer_load_dwordx4 v29, s[32:35], s63 offen offset:1024  lds
v_mfma_f32_16x16x32_bf16 v[140:143], v[204:207], a[32:35], v[140:143]
ds_read_b64_tr_b16 v[198:199], v13 offset:25088
s_waitcnt lgkmcnt(8)
v_mfma_f32_16x16x32_bf16 v[156:159], v[204:207], a[36:39], v[156:159]
ds_read_b64_tr_b16 v[200:201], v14 offset:24576
s_lshl_b32 s4, s48, 11
v_mfma_f32_16x16x32_bf16 v[128:131], v[208:211], a[40:43], v[128:131]
ds_read_b64_tr_b16 v[202:203], v14 offset:25088
s_lshl_b32 s12, s48, 8
v_mfma_f32_16x16x32_bf16 v[144:147], v[208:211], a[44:47], v[144:147]
ds_read_b64_tr_b16 v[204:205], v15 offset:24576
s_add_u32 s48, s46, 1
v_mfma_f32_16x16x32_bf16 v[132:135], v[212:215], a[40:43], v[132:135]
ds_read_b64_tr_b16 v[206:207], v15 offset:25088
s_waitcnt lgkmcnt(8)
v_mfma_f32_16x16x32_bf16 v[148:151], v[212:215], a[44:47], v[148:151]
ds_read_b64_tr_b16 v[208:209], v12 offset:28672
s_and_b32 s48, s48, 7
v_mfma_f32_16x16x32_bf16 v[136:139], v[216:219], a[40:43], v[136:139]
ds_read_b64_tr_b16 v[210:211], v12 offset:29184
s_lshl_b32 s63, s48, 16
v_mfma_f32_16x16x32_bf16 v[152:155], v[216:219], a[44:47], v[152:155]
ds_read_b64_tr_b16 v[212:213], v13 offset:28672
s_add_u32 m0, s22, 40960
v_mfma_f32_16x16x32_bf16 v[140:143], v[220:223], a[40:43], v[140:143]
ds_read_b64_tr_b16 v[214:215], v13 offset:29184
s_waitcnt lgkmcnt(8)
v_mfma_f32_16x16x32_bf16 v[156:159], v[220:223], a[44:47], v[156:159]
ds_read_b64_tr_b16 v[216:217], v14 offset:28672
buffer_load_dwordx4 v28, s[32:35], s63 offen offset:0  lds
v_mfma_f32_16x16x32_bf16 v[128:131], v[192:195], a[48:51], v[128:131]
ds_read_b64_tr_b16 v[218:219], v14 offset:29184
v_mfma_f32_16x16x32_bf16 v[144:147], v[192:195], a[52:55], v[144:147]
ds_read_b64_tr_b16 v[220:221], v15 offset:28672
buffer_load_dwordx4 v29, s[32:35], s63 offen offset:1024  lds
v_mfma_f32_16x16x32_bf16 v[132:135], v[196:199], a[48:51], v[132:135]
ds_read_b64_tr_b16 v[222:223], v15 offset:29184
s_waitcnt lgkmcnt(8)
v_mfma_f32_16x16x32_bf16 v[148:151], v[196:199], a[52:55], v[148:151]
s_waitcnt vmcnt(9)
s_barrier
ds_read_b64_tr_b16 v[192:193], v12 offset:32768
v_mfma_f32_16x16x32_bf16 v[136:139], v[200:203], a[48:51], v[136:139]
ds_read_b64_tr_b16 v[194:195], v12 offset:33280
s_lshl_b32 s5, s48, 11
v_mfma_f32_16x16x32_bf16 v[152:155], v[200:203], a[52:55], v[152:155]
ds_read_b64_tr_b16 v[196:197], v13 offset:32768
s_lshl_b32 s13, s48, 8
v_mfma_f32_16x16x32_bf16 v[140:143], v[204:207], a[48:51], v[140:143]
ds_read_b64_tr_b16 v[198:199], v13 offset:33280
s_waitcnt lgkmcnt(8)
v_mfma_f32_16x16x32_bf16 v[156:159], v[204:207], a[52:55], v[156:159]
ds_read_b64_tr_b16 v[200:201], v14 offset:32768
s_add_u32 s48, s46, 2
v_mfma_f32_16x16x32_bf16 v[128:131], v[208:211], a[56:59], v[128:131]
ds_read_b64_tr_b16 v[202:203], v14 offset:33280
s_and_b32 s48, s48, 7
v_mfma_f32_16x16x32_bf16 v[144:147], v[208:211], a[60:63], v[144:147]
ds_read_b64_tr_b16 v[204:205], v15 offset:32768
s_lshl_b32 s63, s48, 16
v_mfma_f32_16x16x32_bf16 v[132:135], v[212:215], a[56:59], v[132:135]
ds_read_b64_tr_b16 v[206:207], v15 offset:33280
s_waitcnt lgkmcnt(8)
v_mfma_f32_16x16x32_bf16 v[148:151], v[212:215], a[60:63], v[148:151]
ds_read_b64_tr_b16 v[208:209], v12 offset:36864
s_add_u32 m0, s22, 49152
v_mfma_f32_16x16x32_bf16 v[136:139], v[216:219], a[56:59], v[136:139]
ds_read_b64_tr_b16 v[210:211], v12 offset:37376
buffer_load_dwordx4 v28, s[32:35], s63 offen offset:0  lds
v_mfma_f32_16x16x32_bf16 v[152:155], v[216:219], a[60:63], v[152:155]
ds_read_b64_tr_b16 v[212:213], v13 offset:36864
v_mfma_f32_16x16x32_bf16 v[140:143], v[220:223], a[56:59], v[140:143]
ds_read_b64_tr_b16 v[214:215], v13 offset:37376
s_waitcnt lgkmcnt(8)
v_mfma_f32_16x16x32_bf16 v[156:159], v[220:223], a[60:63], v[156:159]
ds_read_b64_tr_b16 v[216:217], v14 offset:36864
buffer_load_dwordx4 v29, s[32:35], s63 offen offset:1024  lds
v_mfma_f32_16x16x32_bf16 v[128:131], v[192:195], a[64:67], v[128:131]
ds_read_b64_tr_b16 v[218:219], v14 offset:37376
s_lshl_b32 s6, s48, 11
v_mfma_f32_16x16x32_bf16 v[144:147], v[192:195], a[68:71], v[144:147]
ds_read_b64_tr_b16 v[220:221], v15 offset:36864
s_lshl_b32 s14, s48, 8
v_mfma_f32_16x16x32_bf16 v[132:135], v[196:199], a[64:67], v[132:135]
ds_read_b64_tr_b16 v[222:223], v15 offset:37376
s_waitcnt lgkmcnt(8)
v_mfma_f32_16x16x32_bf16 v[148:151], v[196:199], a[68:71], v[148:151]
ds_read_b64_tr_b16 v[192:193], v12 offset:40960
s_add_u32 s48, s46, 3
v_mfma_f32_16x16x32_bf16 v[136:139], v[200:203], a[64:67], v[136:139]
ds_read_b64_tr_b16 v[194:195], v12 offset:41472
s_and_b32 s48, s48, 7
v_mfma_f32_16x16x32_bf16 v[152:155], v[200:203], a[68:71], v[152:155]
ds_read_b64_tr_b16 v[196:197], v13 offset:40960
s_lshl_b32 s63, s48, 16
v_mfma_f32_16x16x32_bf16 v[140:143], v[204:207], a[64:67], v[140:143]
ds_read_b64_tr_b16 v[198:199], v13 offset:41472
s_waitcnt lgkmcnt(8)
v_mfma_f32_16x16x32_bf16 v[156:159], v[204:207], a[68:71], v[156:159]
ds_read_b64_tr_b16 v[200:201], v14 offset:40960
s_add_u32 m0, s22, 57344
v_mfma_f32_16x16x32_bf16 v[128:131], v[208:211], a[72:75], v[128:131]
ds_read_b64_tr_b16 v[202:203], v14 offset:41472
buffer_load_dwordx4 v28, s[32:35], s63 offen offset:0  lds
v_mfma_f32_16x16x32_bf16 v[144:147], v[208:211], a[76:79], v[144:147]
ds_read_b64_tr_b16 v[204:205], v15 offset:40960
v_mfma_f32_16x16x32_bf16 v[132:135], v[212:215], a[72:75], v[132:135]
ds_read_b64_tr_b16 v[206:207], v15 offset:41472
s_waitcnt lgkmcnt(8)
v_mfma_f32_16x16x32_bf16 v[148:151], v[212:215], a[76:79], v[148:151]
ds_read_b64_tr_b16 v[208:209], v12 offset:45056
buffer_load_dwordx4 v29, s[32:35], s63 offen offset:1024  lds
v_mfma_f32_16x16x32_bf16 v[136:139], v[216:219], a[72:75], v[136:139]
ds_read_b64_tr_b16 v[210:211], v12 offset:45568
s_lshl_b32 s7, s48, 11
v_mfma_f32_16x16x32_bf16 v[152:155], v[216:219], a[76:79], v[152:155]
ds_read_b64_tr_b16 v[212:213], v13 offset:45056
s_lshl_b32 s15, s48, 8
v_mfma_f32_16x16x32_bf16 v[140:143], v[220:223], a[72:75], v[140:143]
ds_read_b64_tr_b16 v[214:215], v13 offset:45568
s_waitcnt lgkmcnt(8)
v_mfma_f32_16x16x32_bf16 v[156:159], v[220:223], a[76:79], v[156:159]
ds_read_b64_tr_b16 v[216:217], v14 offset:45056
s_add_u32 s48, s46, 4
v_mfma_f32_16x16x32_bf16 v[128:131], v[192:195], a[80:83], v[128:131]
ds_read_b64_tr_b16 v[218:219], v14 offset:45568
s_and_b32 s48, s48, 7
v_mfma_f32_16x16x32_bf16 v[144:147], v[192:195], a[84:87], v[144:147]
ds_read_b64_tr_b16 v[220:221], v15 offset:45056
s_lshl_b32 s63, s48, 16
v_mfma_f32_16x16x32_bf16 v[132:135], v[196:199], a[80:83], v[132:135]
ds_read_b64_tr_b16 v[222:223], v15 offset:45568
s_waitcnt lgkmcnt(8)
v_mfma_f32_16x16x32_bf16 v[148:151], v[196:199], a[84:87], v[148:151]
ds_read_b64_tr_b16 v[192:193], v12 offset:49152
s_add_u32 m0, s22, 65536
v_mfma_f32_16x16x32_bf16 v[136:139], v[200:203], a[80:83], v[136:139]
ds_read_b64_tr_b16 v[194:195], v12 offset:49664
buffer_load_dwordx4 v28, s[32:35], s63 offen offset:0  lds
v_mfma_f32_16x16x32_bf16 v[152:155], v[200:203], a[84:87], v[152:155]
ds_read_b64_tr_b16 v[196:197], v13 offset:49152
v_mfma_f32_16x16x32_bf16 v[140:143], v[204:207], a[80:83], v[140:143]
ds_read_b64_tr_b16 v[198:199], v13 offset:49664
s_waitcnt lgkmcnt(8)
v_mfma_f32_16x16x32_bf16 v[156:159], v[204:207], a[84:87], v[156:159]
ds_read_b64_tr_b16 v[200:201], v14 offset:49152
buffer_load_dwordx4 v29, s[32:35], s63 offen offset:1024  lds
v_mfma_f32_16x16x32_bf16 v[128:131], v[208:211], a[88:91], v[128:131]
ds_read_b64_tr_b16 v[202:203], v14 offset:49664
s_lshl_b32 s8, s48, 11
v_mfma_f32_16x16x32_bf16 v[144:147], v[208:211], a[92:95], v[144:147]
ds_read_b64_tr_b16 v[204:205], v15 offset:49152
s_lshl_b32 s16, s48, 8
v_mfma_f32_16x16x32_bf16 v[132:135], v[212:215], a[88:91], v[132:135]
ds_read_b64_tr_b16 v[206:207], v15 offset:49664
s_waitcnt lgkmcnt(8)
v_mfma_f32_16x16x32_bf16 v[148:151], v[212:215], a[92:95], v[148:151]
ds_read_b64_tr_b16 v[208:209], v12 offset:53248
s_add_u32 s48, s46, 5
v_mfma_f32_16x16x32_bf16 v[136:139], v[216:219], a[88:91], v[136:139]
ds_read_b64_tr_b16 v[210:211], v12 offset:53760
s_and_b32 s48, s48, 7
v_mfma_f32_16x16x32_bf16 v[152:155], v[216:219], a[92:95], v[152:155]
ds_read_b64_tr_b16 v[212:213], v13 offset:53248
s_lshl_b32 s63, s48, 16
v_mfma_f32_16x16x32_bf16 v[140:143], v[220:223], a[88:91], v[140:143]
ds_read_b64_tr_b16 v[214:215], v13 offset:53760
s_waitcnt lgkmcnt(8)
v_mfma_f32_16x16x32_bf16 v[156:159], v[220:223], a[92:95], v[156:159]
ds_read_b64_tr_b16 v[216:217], v14 offset:53248
s_add_u32 m0, s22, 73728
v_mfma_f32_16x16x32_bf16 v[128:131], v[192:195], a[96:99], v[128:131]
ds_read_b64_tr_b16 v[218:219], v14 offset:53760
buffer_load_dwordx4 v28, s[32:35], s63 offen offset:0  lds
v_mfma_f32_16x16x32_bf16 v[144:147], v[192:195], a[100:103], v[144:147]
ds_read_b64_tr_b16 v[220:221], v15 offset:53248
v_mfma_f32_16x16x32_bf16 v[132:135], v[196:199], a[96:99], v[132:135]
ds_read_b64_tr_b16 v[222:223], v15 offset:53760
s_waitcnt lgkmcnt(8)
v_mfma_f32_16x16x32_bf16 v[148:151], v[196:199], a[100:103], v[148:151]
ds_read_b64_tr_b16 v[192:193], v12 offset:57344
buffer_load_dwordx4 v29, s[32:35], s63 offen offset:1024  lds
v_mfma_f32_16x16x32_bf16 v[136:139], v[200:203], a[96:99], v[136:139]
ds_read_b64_tr_b16 v[194:195], v12 offset:57856
s_lshl_b32 s9, s48, 11
v_mfma_f32_16x16x32_bf16 v[152:155], v[200:203], a[100:103], v[152:155]
ds_read_b64_tr_b16 v[196:197], v13 offset:57344
s_lshl_b32 s17, s48, 8
v_mfma_f32_16x16x32_bf16 v[140:143], v[204:207], a[96:99], v[140:143]
ds_read_b64_tr_b16 v[198:199], v13 offset:57856
s_waitcnt lgkmcnt(8)
v_mfma_f32_16x16x32_bf16 v[156:159], v[204:207], a[100:103], v[156:159]
ds_read_b64_tr_b16 v[200:201], v14 offset:57344
s_add_u32 s48, s46, 6
v_mfma_f32_16x16x32_bf16 v[128:131], v[208:211], a[104:107], v[128:131]
ds_read_b64_tr_b16 v[202:203], v14 offset:57856
s_and_b32 s48, s48, 7
v_mfma_f32_16x16x32_bf16 v[144:147], v[208:211], a[108:111], v[144:147]
ds_read_b64_tr_b16 v[204:205], v15 offset:57344
s_lshl_b32 s63, s48, 16
v_mfma_f32_16x16x32_bf16 v[132:135], v[212:215], a[104:107], v[132:135]
ds_read_b64_tr_b16 v[206:207], v15 offset:57856
s_waitcnt lgkmcnt(8)
v_mfma_f32_16x16x32_bf16 v[148:151], v[212:215], a[108:111], v[148:151]
ds_read_b64_tr_b16 v[208:209], v12 offset:61440
s_add_u32 m0, s22, 81920
v_mfma_f32_16x16x32_bf16 v[136:139], v[216:219], a[104:107], v[136:139]
ds_read_b64_tr_b16 v[210:211], v12 offset:61952
buffer_load_dwordx4 v28, s[32:35], s63 offen offset:0  lds
v_mfma_f32_16x16x32_bf16 v[152:155], v[216:219], a[108:111], v[152:155]
ds_read_b64_tr_b16 v[212:213], v13 offset:61440
v_mfma_f32_16x16x32_bf16 v[140:143], v[220:223], a[104:107], v[140:143]
ds_read_b64_tr_b16 v[214:215], v13 offset:61952
s_waitcnt lgkmcnt(8)
v_mfma_f32_16x16x32_bf16 v[156:159], v[220:223], a[108:111], v[156:159]
ds_read_b64_tr_b16 v[216:217], v14 offset:61440
buffer_load_dwordx4 v29, s[32:35], s63 offen offset:1024  lds
v_mfma_f32_16x16x32_bf16 v[128:131], v[192:195], a[112:115], v[128:131]
ds_read_b64_tr_b16 v[218:219], v14 offset:61952
s_lshl_b32 s10, s48, 11
v_mfma_f32_16x16x32_bf16 v[144:147], v[192:195], a[116:119], v[144:147]
ds_read_b64_tr_b16 v[220:221], v15 offset:61440
s_lshl_b32 s18, s48, 8
v_mfma_f32_16x16x32_bf16 v[132:135], v[196:199], a[112:115], v[132:135]
ds_read_b64_tr_b16 v[222:223], v15 offset:61952
s_waitcnt lgkmcnt(8)
v_mfma_f32_16x16x32_bf16 v[148:151], v[196:199], a[116:119], v[148:151]
s_add_u32 s48, s46, 7
s_and_b32 s48, s48, 7
v_mfma_f32_16x16x32_bf16 v[136:139], v[200:203], a[112:115], v[136:139]
s_lshl_b32 s63, s48, 16
s_add_u32 m0, s22, 90112
v_mfma_f32_16x16x32_bf16 v[152:155], v[200:203], a[116:119], v[152:155]
buffer_load_dwordx4 v28, s[32:35], s63 offen offset:0  lds
v_mfma_f32_16x16x32_bf16 v[140:143], v[204:207], a[112:115], v[140:143]
s_waitcnt lgkmcnt(4)
v_mfma_f32_16x16x32_bf16 v[156:159], v[204:207], a[116:119], v[156:159]
buffer_load_dwordx4 v29, s[32:35], s63 offen offset:1024  lds
s_lshl_b32 s11, s48, 11
v_mfma_f32_16x16x32_bf16 v[128:131], v[208:211], a[120:123], v[128:131]
s_lshl_b32 s19, s48, 8
v_mfma_f32_16x16x32_bf16 v[144:147], v[208:211], a[124:127], v[144:147]
buffer_load_dwordx4 v[52:55], v47, s[40:43], 0 offen sc1
v_mfma_f32_16x16x32_bf16 v[132:135], v[212:215], a[120:123], v[132:135]
s_waitcnt lgkmcnt(0)
v_mfma_f32_16x16x32_bf16 v[148:151], v[212:215], a[124:127], v[148:151]
buffer_load_dword v242, v243, s[40:43], 0 offen sc1
v_mfma_f32_16x16x32_bf16 v[136:139], v[216:219], a[120:123], v[136:139]
v_mfma_f32_16x16x32_bf16 v[152:155], v[216:219], a[124:127], v[152:155]
buffer_load_dwordx4 v[64:67], v46, s[40:43], 0 offen offset:0 sc1
v_mfma_f32_16x16x32_bf16 v[140:143], v[220:223], a[120:123], v[140:143]
v_mfma_f32_16x16x32_bf16 v[156:159], v[220:223], a[124:127], v[156:159]
buffer_load_dwordx4 v[68:71], v46, s[40:43], 0 offen offset:1024 sc1
s_nop 0
buffer_load_dwordx4 v[72:75], v46, s[40:43], 0 offen offset:2048 sc1
s_nop 0
buffer_load_dwordx4 v[76:79], v46, s[40:43], 0 offen offset:3072 sc1
s_nop 0
buffer_load_dwordx4 v[80:83], v46, s[40:43], s3 offen offset:0 sc1
s_nop 0
buffer_load_dwordx4 v[84:87], v46, s[40:43], s3 offen offset:1024 sc1
s_nop 0
buffer_load_dwordx4 v[88:91], v46, s[40:43], s3 offen offset:2048 sc1
s_nop 0
buffer_load_dwordx4 v[92:95], v46, s[40:43], s3 offen offset:3072 sc1
s_nop 0
buffer_load_dwordx4 v[96:99], v46, s[40:43], s20 offen offset:0 sc1
s_nop 0
buffer_load_dwordx4 v[100:103], v46, s[40:43], s20 offen offset:1024 sc1
s_nop 0
buffer_load_dwordx4 v[104:107], v46, s[40:43], s20 offen offset:2048 sc1
s_nop 0
buffer_load_dwordx4 v[108:111], v46, s[40:43], s20 offen offset:3072 sc1
s_nop 0
buffer_load_dwordx4 v[112:115], v46, s[40:43], s21 offen offset:0 sc1
s_nop 0
buffer_load_dwordx4 v[116:119], v46, s[40:43], s21 offen offset:1024 sc1
s_nop 0
buffer_load_dwordx4 v[120:123], v46, s[40:43], s21 offen offset:2048 sc1
s_nop 0
buffer_load_dwordx4 v[124:127], v46, s[40:43], s21 offen offset:3072 sc1
s_nop 0
s_nop 7
v_pk_mul_f32 v[32:33], v[128:129], s[56:57]
v_pk_add_f32 v[34:35], v[128:129], s[58:59]
v_exp_f32 v32, v32 clamp
v_exp_f32 v33, v33 clamp
v_pk_mul_f32 v[36:37], v[130:131], s[56:57]
v_pk_add_f32 v[38:39], v[130:131], s[58:59]
v_exp_f32 v36, v36 clamp
v_exp_f32 v37, v37 clamp
v_pk_add_f32 v[32:33], v[32:33], s[60:61]
v_max_f32 v34, v34, v32
v_max_f32 v35, v35, v33
v_cvt_pk_bf16_f32 v224, v34, v35
v_pk_mul_f32 v[40:41], v[132:133], s[56:57]
v_pk_add_f32 v[42:43], v[132:133], s[58:59]
v_exp_f32 v40, v40 clamp
v_exp_f32 v41, v41 clamp
v_pk_add_f32 v[36:37], v[36:37], s[60:61]
v_max_f32 v38, v38, v36
v_max_f32 v39, v39, v37
v_cvt_pk_bf16_f32 v225, v38, v39
v_pk_mul_f32 v[32:33], v[134:135], s[56:57]
v_pk_add_f32 v[34:35], v[134:135], s[58:59]
v_exp_f32 v32, v32 clamp
v_exp_f32 v33, v33 clamp
v_pk_add_f32 v[40:41], v[40:41], s[60:61]
v_max_f32 v42, v42, v40
v_max_f32 v43, v43, v41
v_cvt_pk_bf16_f32 v226, v42, v43
v_pk_mul_f32 v[36:37], v[136:137], s[56:57]
v_pk_add_f32 v[38:39], v[136:137], s[58:59]
v_exp_f32 v36, v36 clamp
v_exp_f32 v37, v37 clamp
v_pk_add_f32 v[32:33], v[32:33], s[60:61]
v_max_f32 v34, v34, v32
v_max_f32 v35, v35, v33
v_cvt_pk_bf16_f32 v227, v34, v35
v_pk_mul_f32 v[40:41], v[138:139], s[56:57]
v_pk_add_f32 v[42:43], v[138:139], s[58:59]
v_exp_f32 v40, v40 clamp
v_exp_f32 v41, v41 clamp
v_pk_add_f32 v[36:37], v[36:37], s[60:61]
v_max_f32 v38, v38, v36
v_max_f32 v39, v39, v37
v_cvt_pk_bf16_f32 v228, v38, v39
v_pk_mul_f32 v[32:33], v[140:141], s[56:57]
v_pk_add_f32 v[34:35], v[140:141], s[58:59]
v_exp_f32 v32, v32 clamp
v_exp_f32 v33, v33 clamp
v_pk_add_f32 v[40:41], v[40:41], s[60:61]
v_max_f32 v42, v42, v40
v_max_f32 v43, v43, v41
v_cvt_pk_bf16_f32 v229, v42, v43
v_pk_mul_f32 v[36:37], v[142:143], s[56:57]
v_pk_add_f32 v[38:39], v[142:143], s[58:59]
v_exp_f32 v36, v36 clamp
v_exp_f32 v37, v37 clamp
v_pk_add_f32 v[32:33], v[32:33], s[60:61]
v_max_f32 v34, v34, v32
v_max_f32 v35, v35, v33
v_cvt_pk_bf16_f32 v230, v34, v35
v_pk_mul_f32 v[40:41], v[144:145], s[56:57]
v_pk_add_f32 v[42:43], v[144:145], s[58:59]
v_exp_f32 v40, v40 clamp
v_exp_f32 v41, v41 clamp
v_pk_add_f32 v[36:37], v[36:37], s[60:61]
v_max_f32 v38, v38, v36
v_max_f32 v39, v39, v37
v_cvt_pk_bf16_f32 v231, v38, v39
v_pk_mul_f32 v[32:33], v[146:147], s[56:57]
v_pk_add_f32 v[34:35], v[146:147], s[58:59]
v_exp_f32 v32, v32 clamp
v_exp_f32 v33, v33 clamp
v_pk_add_f32 v[40:41], v[40:41], s[60:61]
v_max_f32 v42, v42, v40
v_max_f32 v43, v43, v41
v_cvt_pk_bf16_f32 v232, v42, v43
v_pk_mul_f32 v[36:37], v[148:149], s[56:57]
v_pk_add_f32 v[38:39], v[148:149], s[58:59]
v_exp_f32 v36, v36 clamp
v_exp_f32 v37, v37 clamp
v_pk_add_f32 v[32:33], v[32:33], s[60:61]
v_max_f32 v34, v34, v32
v_max_f32 v35, v35, v33
v_cvt_pk_bf16_f32 v233, v34, v35
v_pk_mul_f32 v[40:41], v[150:151], s[56:57]
v_pk_add_f32 v[42:43], v[150:151], s[58:59]
v_exp_f32 v40, v40 clamp
v_exp_f32 v41, v41 clamp
v_pk_add_f32 v[36:37], v[36:37], s[60:61]
v_max_f32 v38, v38, v36
v_max_f32 v39, v39, v37
v_cvt_pk_bf16_f32 v234, v38, v39
v_pk_mul_f32 v[32:33], v[152:153], s[56:57]
v_pk_add_f32 v[34:35], v[152:153], s[58:59]
v_exp_f32 v32, v32 clamp
v_exp_f32 v33, v33 clamp
v_pk_add_f32 v[40:41], v[40:41], s[60:61]
v_max_f32 v42, v42, v40
v_max_f32 v43, v43, v41
v_cvt_pk_bf16_f32 v235, v42, v43
v_pk_mul_f32 v[36:37], v[154:155], s[56:57]
v_pk_add_f32 v[38:39], v[154:155], s[58:59]
v_exp_f32 v36, v36 clamp
v_exp_f32 v37, v37 clamp
v_pk_add_f32 v[32:33], v[32:33], s[60:61]
v_max_f32 v34, v34, v32
v_max_f32 v35, v35, v33
v_cvt_pk_bf16_f32 v236, v34, v35
v_pk_mul_f32 v[40:41], v[156:157], s[56:57]
v_pk_add_f32 v[42:43], v[156:157], s[58:59]
v_exp_f32 v40, v40 clamp
v_exp_f32 v41, v41 clamp
v_pk_add_f32 v[36:37], v[36:37], s[60:61]
v_max_f32 v38, v38, v36
v_max_f32 v39, v39, v37
v_cvt_pk_bf16_f32 v237, v38, v39
v_pk_mul_f32 v[32:33], v[158:159], s[56:57]
v_pk_add_f32 v[34:35], v[158:159], s[58:59]
v_exp_f32 v32, v32 clamp
v_exp_f32 v33, v33 clamp
v_pk_add_f32 v[40:41], v[40:41], s[60:61]
v_max_f32 v42, v42, v40
v_max_f32 v43, v43, v41
v_cvt_pk_bf16_f32 v238, v42, v43
s_nop 0
v_pk_add_f32 v[32:33], v[32:33], s[60:61]
v_max_f32 v34, v34, v32
v_max_f32 v35, v35, v33
v_cvt_pk_bf16_f32 v239, v34, v35
L_chkA:
s_waitcnt vmcnt(0)
v_xor_b32 v50, v48, v52
v_xor_b32 v51, v48, v55
v_bitop3_b32 v50, v50, v67, v48 bitop3:0xf6
v_bitop3_b32 v51, v51, v71, v48 bitop3:0xf6
v_bitop3_b32 v50, v50, v75, v48 bitop3:0xf6
v_bitop3_b32 v51, v51, v79, v48 bitop3:0xf6
v_bitop3_b32 v50, v50, v83, v48 bitop3:0xf6
v_bitop3_b32 v51, v51, v87, v48 bitop3:0xf6
v_bitop3_b32 v50, v50, v91, v48 bitop3:0xf6
v_bitop3_b32 v51, v51, v95, v48 bitop3:0xf6
v_bitop3_b32 v50, v50, v99, v48 bitop3:0xf6
v_bitop3_b32 v51, v51, v103, v48 bitop3:0xf6
v_bitop3_b32 v50, v50, v107, v48 bitop3:0xf6
v_bitop3_b32 v51, v51, v111, v48 bitop3:0xf6
v_bitop3_b32 v50, v50, v115, v48 bitop3:0xf6
v_bitop3_b32 v51, v51, v119, v48 bitop3:0xf6
v_bitop3_b32 v50, v50, v123, v48 bitop3:0xf6
v_bitop3_b32 v51, v51, v127, v48 bitop3:0xf6
v_or_b32 v50, v50, v51
v_and_b32 v50, 0xff, v50
v_cmp_ne_u32 vcc, 0, v50
s_add_u32 s98, s98, 1
s_cbranch_vccz L_okA
s_cmp_gt_u32 s98, 20000
s_cbranch_scc1 L_okA
buffer_load_dwordx4 v[52:55], v47, s[40:43], 0 offen sc1
buffer_load_dword v242, v243, s[40:43], 0 offen sc1
buffer_load_dwordx4 v[64:67], v46, s[40:43], 0 offen offset:0 sc1
buffer_load_dwordx4 v[68:71], v46, s[40:43], 0 offen offset:1024 sc1
buffer_load_dwordx4 v[72:75], v46, s[40:43], 0 offen offset:2048 sc1
buffer_load_dwordx4 v[76:79], v46, s[40:43], 0 offen offset:3072 sc1
buffer_load_dwordx4 v[80:83], v46, s[40:43], s3 offen offset:0 sc1
buffer_load_dwordx4 v[84:87], v46, s[40:43], s3 offen offset:1024 sc1
buffer_load_dwordx4 v[88:91], v46, s[40:43], s3 offen offset:2048 sc1
buffer_load_dwordx4 v[92:95], v46, s[40:43], s3 offen offset:3072 sc1
buffer_load_dwordx4 v[96:99], v46, s[40:43], s20 offen offset:0 sc1
buffer_load_dwordx4 v[100:103], v46, s[40:43], s20 offen offset:1024 sc1
buffer_load_dwordx4 v[104:107], v46, s[40:43], s20 offen offset:2048 sc1
buffer_load_dwordx4 v[108:111], v46, s[40:43], s20 offen offset:3072 sc1
buffer_load_dwordx4 v[112:115], v46, s[40:43], s21 offen offset:0 sc1
buffer_load_dwordx4 v[116:119], v46, s[40:43], s21 offen offset:1024 sc1
buffer_load_dwordx4 v[120:123], v46, s[40:43], s21 offen offset:2048 sc1
buffer_load_dwordx4 v[124:127], v46, s[40:43], s21 offen offset:3072 sc1
s_branch L_chkA
L_okA:
v_add_f32_dpp v52, v52, v52 row_ror:8 row_mask:0xf bank_mask:0xf
v_add_f32_dpp v53, v53, v53 row_ror:8 row_mask:0xf bank_mask:0xf
v_add_f32_dpp v54, v54, v54 row_ror:8 row_mask:0xf bank_mask:0xf
v_add_f32_dpp v55, v55, v55 row_ror:8 row_mask:0xf bank_mask:0xf
v_add_f32_dpp v52, v52, v52 row_ror:4 row_mask:0xf bank_mask:0xf
v_add_f32_dpp v53, v53, v53 row_ror:4 row_mask:0xf bank_mask:0xf
v_add_f32_dpp v54, v54, v54 row_ror:4 row_mask:0xf bank_mask:0xf
v_add_f32_dpp v55, v55, v55 row_ror:4 row_mask:0xf bank_mask:0xf
v_add_f32_dpp v52, v52, v52 row_ror:2 row_mask:0xf bank_mask:0xf
v_add_f32_dpp v53, v53, v53 row_ror:2 row_mask:0xf bank_mask:0xf
v_add_f32_dpp v54, v54, v54 row_ror:2 row_mask:0xf bank_mask:0xf
v_add_f32_dpp v55, v55, v55 row_ror:2 row_mask:0xf bank_mask:0xf
v_add_f32_dpp v52, v52, v52 row_ror:1 row_mask:0xf bank_mask:0xf
v_add_f32_dpp v53, v53, v53 row_ror:1 row_mask:0xf bank_mask:0xf
v_add_f32_dpp v54, v54, v54 row_ror:1 row_mask:0xf bank_mask:0xf
v_add_f32_dpp v55, v55, v55 row_ror:1 row_mask:0xf bank_mask:0xf
v_pk_add_f32 v[64:65], v[64:65], v[96:97]
v_pk_add_f32 v[66:67], v[66:67], v[98:99]
v_pk_add_f32 v[68:69], v[68:69], v[100:101]
v_pk_add_f32 v[70:71], v[70:71], v[102:103]
v_pk_add_f32 v[72:73], v[72:73], v[104:105]
v_pk_add_f32 v[74:75], v[74:75], v[106:107]
v_pk_add_f32 v[76:77], v[76:77], v[108:109]
v_pk_add_f32 v[78:79], v[78:79], v[110:111]
v_pk_add_f32 v[80:81], v[80:81], v[112:113]
v_pk_add_f32 v[82:83], v[82:83], v[114:115]
v_pk_add_f32 v[84:85], v[84:85], v[116:117]
v_pk_add_f32 v[86:87], v[86:87], v[118:119]
v_pk_add_f32 v[88:89], v[88:89], v[120:121]
v_pk_add_f32 v[90:91], v[90:91], v[122:123]
v_pk_add_f32 v[92:93], v[92:93], v[124:125]
v_pk_add_f32 v[94:95], v[94:95], v[126:127]
v_pk_add_f32 v[64:65], v[64:65], v[80:81]
v_pk_add_f32 v[66:67], v[66:67], v[82:83]
v_pk_add_f32 v[68:69], v[68:69], v[84:85]
v_pk_add_f32 v[70:71], v[70:71], v[86:87]
v_pk_add_f32 v[72:73], v[72:73], v[88:89]
v_pk_add_f32 v[74:75], v[74:75], v[90:91]
v_pk_add_f32 v[76:77], v[76:77], v[92:93]
v_pk_add_f32 v[78:79], v[78:79], v[94:95]
v_pk_add_f32 v[64:65], v[64:65], v[72:73]
v_pk_add_f32 v[66:67], v[66:67], v[74:75]
v_pk_add_f32 v[68:69], v[68:69], v[76:77]
v_pk_add_f32 v[70:71], v[70:71], v[78:79]
v_pk_add_f32 v[64:65], v[64:65], v[68:69]
v_pk_add_f32 v[66:67], v[66:67], v[70:71]
v_cvt_pk_bf16_f32 v70, v52, v53
v_cvt_pk_bf16_f32 v71, v54, v55
v_cvt_pk_bf16_f32 v68, v64, v65
v_cvt_pk_bf16_f32 v69, v66, v67
ds_write_b128 v251, v[68:71]
v_cmp_ne_u32 vcc, v242, v244
s_nop 1
s_cmp_eq_u64 vcc, 0
s_cselect_b32 s95, 1, 0
s_waitcnt lgkmcnt(0)
s_barrier
ds_read_b128 v[80:83], v252 offset:20480
ds_read_b128 v[84:87], v252 offset:21504
ds_read_b128 v[88:91], v252 offset:22528
ds_read_b128 v[92:95], v252 offset:23552
s_waitcnt lgkmcnt(3)
v_mfma_f32_16x16x16_bf16 v[160:163], v[82:83], v[224:225], v[60:63]
ds_read_b64_tr_b16 a[0:1], v16 offset:0
ds_read_b64_tr_b16 a[2:3], v16 offset:2048
v_mfma_f32_16x16x16_bf16 v[128:131], v[80:81], v[224:225], 0
ds_read_b64_tr_b16 a[4:5], v17 offset:0
ds_read_b64_tr_b16 a[6:7], v17 offset:2048
v_mfma_f32_16x16x16_bf16 v[176:179], v[82:83], v[232:233], v[60:63]
ds_read_b64_tr_b16 a[8:9], v18 offset:0
ds_read_b64_tr_b16 a[10:11], v18 offset:2048
v_mfma_f32_16x16x16_bf16 v[144:147], v[80:81], v[232:233], 0
ds_read_b64_tr_b16 a[12:13], v19 offset:0
ds_read_b64_tr_b16 a[14:15], v19 offset:2048
s_waitcnt lgkmcnt(10)
v_mfma_f32_16x16x16_bf16 v[164:167], v[86:87], v[226:227], v[60:63]
ds_read_b64_tr_b16 a[16:17], v16 offset:4096
ds_read_b64_tr_b16 a[18:19], v16 offset:6144
v_mfma_f32_16x16x16_bf16 v[132:135], v[84:85], v[226:227], 0
ds_read_b64_tr_b16 a[20:21], v17 offset:4096
ds_read_b64_tr_b16 a[22:23], v17 offset:6144
v_mfma_f32_16x16x16_bf16 v[180:183], v[86:87], v[234:235], v[60:63]
ds_read_b64_tr_b16 a[24:25], v18 offset:4096
ds_read_b64_tr_b16 a[26:27], v18 offset:6144
v_mfma_f32_16x16x16_bf16 v[148:151], v[84:85], v[234:235], 0
ds_read_b64_tr_b16 a[28:29], v19 offset:4096
ds_read_b64_tr_b16 a[30:31], v19 offset:6144
s_waitcnt lgkmcnt(15)
v_mfma_f32_16x16x16_bf16 v[168:171], v[90:91], v[228:229], v[60:63]
ds_read_b64_tr_b16 a[32:33], v16 offset:8192
ds_read_b64_tr_b16 a[34:35], v16 offset:10240
v_mfma_f32_16x16x16_bf16 v[136:139], v[88:89], v[228:229], 0
ds_read_b64_tr_b16 a[36:37], v17 offset:8192
ds_read_b64_tr_b16 a[38:39], v17 offset:10240
v_mfma_f32_16x16x16_bf16 v[184:187], v[90:91], v[236:237], v[60:63]
ds_read_b64_tr_b16 a[40:41], v18 offset:8192
ds_read_b64_tr_b16 a[42:43], v18 offset:10240
v_mfma_f32_16x16x16_bf16 v[152:155], v[88:89], v[236:237], 0
ds_read_b64_tr_b16 a[44:45], v19 offset:8192
ds_read_b64_tr_b16 a[46:47], v19 offset:10240
s_waitcnt lgkmcnt(15)
v_mfma_f32_16x16x16_bf16 v[172:175], v[94:95], v[230:231], v[60:63]
ds_read_b64_tr_b16 a[48:49], v16 offset:12288
ds_read_b64_tr_b16 a[50:51], v16 offset:14336
v_mfma_f32_16x16x16_bf16 v[140:143], v[92:93], v[230:231], 0
ds_read_b64_tr_b16 a[52:53], v17 offset:12288
ds_read_b64_tr_b16 a[54:55], v17 offset:14336
v_mfma_f32_16x16x16_bf16 v[188:191], v[94:95], v[238:239], v[60:63]
ds_read_b64_tr_b16 a[56:57], v18 offset:12288
ds_read_b64_tr_b16 a[58:59], v18 offset:14336
v_mfma_f32_16x16x16_bf16 v[156:159], v[92:93], v[238:239], 0
ds_read_b64_tr_b16 a[60:61], v19 offset:12288
ds_read_b64_tr_b16 a[62:63], v19 offset:14336
v_rcp_f32 v160, v160
v_rcp_f32 v176, v176
v_rcp_f32 v164, v164
v_rcp_f32 v180, v180
s_nop 3
v_rcp_f32 v168, v168
v_rcp_f32 v184, v184
v_rcp_f32 v172, v172
v_rcp_f32 v188, v188
v_pk_mul_f32 v[128:129], v[128:129], v[160:161] op_sel_hi:[1,0]
v_pk_mul_f32 v[130:131], v[130:131], v[160:161] op_sel_hi:[1,0]
v_cvt_pk_bf16_f32 v192, v128, v129
v_cvt_pk_bf16_f32 v193, v130, v131
v_pk_mul_f32 v[144:145], v[144:145], v[176:177] op_sel_hi:[1,0]
v_pk_mul_f32 v[146:147], v[146:147], v[176:177] op_sel_hi:[1,0]
v_cvt_pk_bf16_f32 v200, v144, v145
v_cvt_pk_bf16_f32 v201, v146, v147
v_pk_mul_f32 v[132:133], v[132:133], v[164:165] op_sel_hi:[1,0]
v_pk_mul_f32 v[134:135], v[134:135], v[164:165] op_sel_hi:[1,0]
v_cvt_pk_bf16_f32 v194, v132, v133
v_cvt_pk_bf16_f32 v195, v134, v135
v_pk_mul_f32 v[148:149], v[148:149], v[180:181] op_sel_hi:[1,0]
v_pk_mul_f32 v[150:151], v[150:151], v[180:181] op_sel_hi:[1,0]
v_cvt_pk_bf16_f32 v202, v148, v149
v_cvt_pk_bf16_f32 v203, v150, v151
v_pk_mul_f32 v[136:137], v[136:137], v[168:169] op_sel_hi:[1,0]
v_pk_mul_f32 v[138:139], v[138:139], v[168:169] op_sel_hi:[1,0]
v_cvt_pk_bf16_f32 v196, v136, v137
v_cvt_pk_bf16_f32 v197, v138, v139
v_pk_mul_f32 v[152:153], v[152:153], v[184:185] op_sel_hi:[1,0]
v_pk_mul_f32 v[154:155], v[154:155], v[184:185] op_sel_hi:[1,0]
v_cvt_pk_bf16_f32 v204, v152, v153
v_cvt_pk_bf16_f32 v205, v154, v155
v_pk_mul_f32 v[140:141], v[140:141], v[172:173] op_sel_hi:[1,0]
v_pk_mul_f32 v[142:143], v[142:143], v[172:173] op_sel_hi:[1,0]
v_cvt_pk_bf16_f32 v198, v140, v141
v_cvt_pk_bf16_f32 v199, v142, v143
v_pk_mul_f32 v[156:157], v[156:157], v[188:189] op_sel_hi:[1,0]
v_pk_mul_f32 v[158:159], v[158:159], v[188:189] op_sel_hi:[1,0]
v_cvt_pk_bf16_f32 v206, v156, v157
v_cvt_pk_bf16_f32 v207, v158, v159
v_add3_u32 v32, v192, v193, v48
v_add3_u32 v32, v194, v195, v32
v_add3_u32 v32, v196, v197, v32
v_add3_u32 v32, v198, v199, v32
v_add3_u32 v32, v200, v201, v32
v_add3_u32 v32, v202, v203, v32
v_add3_u32 v32, v204, v205, v32
v_add3_u32 v32, v206, v207, v32
s_cmp_eq_u32 s95, 0
s_cbranch_scc1 L_st_remote
buffer_store_dwordx4 v[192:195], v240, s[40:43], 0 offen offset:0
buffer_store_dwordx4 v[200:203], v240, s[40:43], s52 offen offset:0
buffer_store_dwordx4 v[196:199], v240, s[40:43], 0 offen offset:1024
buffer_store_dwordx4 v[204:207], v240, s[40:43], s52 offen offset:1024
buffer_store_dword v32, v241, s[40:43], 0 offen
L_st_done:
v_mov_b32 v46, v255
ds_read_b64_tr_b16 a[64:65], v16 offset:16384
ds_read_b64_tr_b16 a[66:67], v16 offset:18432
ds_read_b64_tr_b16 a[68:69], v17 offset:16384
ds_read_b64_tr_b16 a[70:71], v17 offset:18432
ds_read_b64_tr_b16 a[72:73], v18 offset:16384
ds_read_b64_tr_b16 a[74:75], v18 offset:18432
ds_read_b64_tr_b16 a[76:77], v19 offset:16384
ds_read_b64_tr_b16 a[78:79], v19 offset:18432
ds_read_b64_tr_b16 a[80:81], v16 offset:20480
ds_read_b64_tr_b16 a[82:83], v16 offset:22528
ds_read_b64_tr_b16 a[84:85], v17 offset:20480
ds_read_b64_tr_b16 a[86:87], v17 offset:22528
ds_read_b64_tr_b16 a[88:89], v18 offset:20480
ds_read_b64_tr_b16 a[90:91], v18 offset:22528
ds_read_b64_tr_b16 a[92:93], v19 offset:20480
ds_read_b64_tr_b16 a[94:95], v19 offset:22528
ds_read_b64_tr_b16 a[96:97], v16 offset:24576
ds_read_b64_tr_b16 a[98:99], v16 offset:26624
ds_read_b64_tr_b16 a[100:101], v17 offset:24576
ds_read_b64_tr_b16 a[102:103], v17 offset:26624
ds_read_b64_tr_b16 a[104:105], v18 offset:24576
ds_read_b64_tr_b16 a[106:107], v18 offset:26624
ds_read_b64_tr_b16 a[108:109], v19 offset:24576
ds_read_b64_tr_b16 a[110:111], v19 offset:26624
ds_read_b64_tr_b16 a[112:113], v16 offset:28672
ds_read_b64_tr_b16 a[114:115], v16 offset:30720
ds_read_b64_tr_b16 a[116:117], v17 offset:28672
ds_read_b64_tr_b16 a[118:119], v17 offset:30720
ds_read_b64_tr_b16 a[120:121], v18 offset:28672
ds_read_b64_tr_b16 a[122:123], v18 offset:30720
ds_read_b64_tr_b16 a[124:125], v19 offset:28672
ds_read_b64_tr_b16 a[126:127], v19 offset:30720
ds_read_b64_tr_b16 a[128:129], v16 offset:32768
ds_read_b64_tr_b16 a[130:131], v16 offset:34816
ds_read_b64_tr_b16 a[132:133], v17 offset:32768
ds_read_b64_tr_b16 a[134:135], v17 offset:34816
ds_read_b64_tr_b16 a[136:137], v18 offset:32768
ds_read_b64_tr_b16 a[138:139], v18 offset:34816
ds_read_b64_tr_b16 a[140:141], v19 offset:32768
ds_read_b64_tr_b16 a[142:143], v19 offset:34816
ds_read_b64_tr_b16 a[144:145], v16 offset:36864
ds_read_b64_tr_b16 a[146:147], v16 offset:38912
ds_read_b64_tr_b16 a[148:149], v17 offset:36864
ds_read_b64_tr_b16 a[150:151], v17 offset:38912
ds_read_b64_tr_b16 a[152:153], v18 offset:36864
ds_read_b64_tr_b16 a[154:155], v18 offset:38912
ds_read_b64_tr_b16 a[156:157], v19 offset:36864
ds_read_b64_tr_b16 a[158:159], v19 offset:38912
ds_read_b64_tr_b16 a[160:161], v16 offset:40960
ds_read_b64_tr_b16 a[162:163], v16 offset:43008
ds_read_b64_tr_b16 a[164:165], v17 offset:40960
ds_read_b64_tr_b16 a[166:167], v17 offset:43008
ds_read_b64_tr_b16 a[168:169], v18 offset:40960
ds_read_b64_tr_b16 a[170:171], v18 offset:43008
ds_read_b64_tr_b16 a[172:173], v19 offset:40960
ds_read_b64_tr_b16 a[174:175], v19 offset:43008
ds_read_b64_tr_b16 a[176:177], v16 offset:45056
ds_read_b64_tr_b16 a[178:179], v16 offset:47104
ds_read_b64_tr_b16 a[180:181], v17 offset:45056
ds_read_b64_tr_b16 a[182:183], v17 offset:47104
ds_read_b64_tr_b16 a[184:185], v18 offset:45056
ds_read_b64_tr_b16 a[186:187], v18 offset:47104
ds_read_b64_tr_b16 a[188:189], v19 offset:45056
ds_read_b64_tr_b16 a[190:191], v19 offset:47104
ds_read_b64_tr_b16 a[192:193], v16 offset:49152
ds_read_b64_tr_b16 a[194:195], v16 offset:51200
ds_read_b64_tr_b16 a[196:197], v17 offset:49152
ds_read_b64_tr_b16 a[198:199], v17 offset:51200
ds_read_b64_tr_b16 a[200:201], v18 offset:49152
ds_read_b64_tr_b16 a[202:203], v18 offset:51200
ds_read_b64_tr_b16 a[204:205], v19 offset:49152
ds_read_b64_tr_b16 a[206:207], v19 offset:51200
ds_read_b64_tr_b16 a[208:209], v16 offset:53248
ds_read_b64_tr_b16 a[210:211], v16 offset:55296
ds_read_b64_tr_b16 a[212:213], v17 offset:53248
ds_read_b64_tr_b16 a[214:215], v17 offset:55296
ds_read_b64_tr_b16 a[216:217], v18 offset:53248
ds_read_b64_tr_b16 a[218:219], v18 offset:55296
ds_read_b64_tr_b16 a[220:221], v19 offset:53248
ds_read_b64_tr_b16 a[222:223], v19 offset:55296
buffer_load_dwordx4 v[64:67], v44, s[40:43], s5 offen offset:0
ds_read_b64_tr_b16 a[224:225], v16 offset:57344
ds_read_b64_tr_b16 a[226:227], v16 offset:59392
buffer_load_dwordx4 v[72:75], v46, s[40:43], s5 offen offset:0
ds_read_b64_tr_b16 a[228:229], v17 offset:57344
ds_read_b64_tr_b16 a[230:231], v17 offset:59392
buffer_load_dwordx4 v[68:71], v44, s[40:43], s5 offen offset:1024
ds_read_b64_tr_b16 a[232:233], v18 offset:57344
ds_read_b64_tr_b16 a[234:235], v18 offset:59392
buffer_load_dwordx4 v[76:79], v46, s[40:43], s5 offen offset:1024
ds_read_b64_tr_b16 a[236:237], v19 offset:57344
ds_read_b64_tr_b16 a[238:239], v19 offset:59392
buffer_load_dword v35, v45, s[40:43], s13 offen
ds_read_b64_tr_b16 a[240:241], v16 offset:61440
ds_read_b64_tr_b16 a[242:243], v16 offset:63488
buffer_load_dwordx4 v[80:83], v44, s[40:43], s6 offen offset:0
ds_read_b64_tr_b16 a[244:245], v17 offset:61440
ds_read_b64_tr_b16 a[246:247], v17 offset:63488
buffer_load_dwordx4 v[88:91], v46, s[40:43], s6 offen offset:0
ds_read_b64_tr_b16 a[248:249], v18 offset:61440
ds_read_b64_tr_b16 a[250:251], v18 offset:63488
buffer_load_dwordx4 v[84:87], v44, s[40:43], s6 offen offset:1024
ds_read_b64_tr_b16 a[252:253], v19 offset:61440
ds_read_b64_tr_b16 a[254:255], v19 offset:63488
buffer_load_dwordx4 v[92:95], v46, s[40:43], s6 offen offset:1024
s_lshl_b32 s101, s47, 8
s_add_u32 s101, s101, s2
s_waitcnt lgkmcnt(15)
buffer_load_dword v36, v45, s[40:43], s14 offen
v_mfma_f32_16x16x32_bf16 v[224:227], a[0:3], v[192:195], 0
v_mfma_f32_16x16x32_bf16 v[240:243], a[0:3], v[200:203], 0
buffer_load_dwordx4 v[96:99], v44, s[40:43], s7 offen offset:0
v_mfma_f32_16x16x32_bf16 v[228:231], a[4:7], v[192:195], 0
v_mfma_f32_16x16x32_bf16 v[244:247], a[4:7], v[200:203], 0
buffer_load_dwordx4 v[104:107], v46, s[40:43], s7 offen offset:0
v_mfma_f32_16x16x32_bf16 v[232:235], a[8:11], v[192:195], 0
v_mfma_f32_16x16x32_bf16 v[248:251], a[8:11], v[200:203], 0
s_waitcnt vmcnt(7)
v_add3_u32 v50, v64, v65, v48
buffer_load_dwordx4 v[100:103], v44, s[40:43], s7 offen offset:1024
v_mfma_f32_16x16x32_bf16 v[236:239], a[12:15], v[192:195], 0
v_add3_u32 v50, v66, v67, v50
v_mfma_f32_16x16x32_bf16 v[252:255], a[12:15], v[200:203], 0
v_add3_u32 v50, v68, v69, v50
buffer_load_dwordx4 v[108:111], v46, s[40:43], s7 offen offset:1024
v_mfma_f32_16x16x32_bf16 v[224:227], a[16:19], v[196:199], v[224:227]
v_add3_u32 v50, v70, v71, v50
v_mfma_f32_16x16x32_bf16 v[240:243], a[16:19], v[204:207], v[240:243]
v_add3_u32 v50, v72, v73, v50
buffer_load_dword v37, v45, s[40:43], s15 offen
v_mfma_f32_16x16x32_bf16 v[228:231], a[20:23], v[196:199], v[228:231]
v_add3_u32 v50, v74, v75, v50
v_mfma_f32_16x16x32_bf16 v[244:247], a[20:23], v[204:207], v[244:247]
v_add3_u32 v50, v76, v77, v50
buffer_load_dwordx4 v[112:115], v44, s[40:43], s8 offen offset:0
v_mfma_f32_16x16x32_bf16 v[232:235], a[24:27], v[196:199], v[232:235]
v_add3_u32 v50, v78, v79, v50
v_mfma_f32_16x16x32_bf16 v[248:251], a[24:27], v[204:207], v[248:251]
v_cmp_ne_u32 vcc, v50, v35
buffer_load_dwordx4 v[120:123], v46, s[40:43], s8 offen offset:0
v_mfma_f32_16x16x32_bf16 v[236:239], a[28:31], v[196:199], v[236:239]
s_cbranch_vccnz L_rt1
L_back1:
v_mfma_f32_16x16x32_bf16 v[252:255], a[28:31], v[204:207], v[252:255]
s_waitcnt lgkmcnt(0)
buffer_load_dwordx4 v[116:119], v44, s[40:43], s8 offen offset:1024
v_mfma_f32_16x16x32_bf16 v[224:227], a[32:35], v[64:67], v[224:227]
v_mfma_f32_16x16x32_bf16 v[240:243], a[32:35], v[72:75], v[240:243]
buffer_load_dwordx4 v[124:127], v46, s[40:43], s8 offen offset:1024
v_mfma_f32_16x16x32_bf16 v[228:231], a[36:39], v[64:67], v[228:231]
v_mfma_f32_16x16x32_bf16 v[244:247], a[36:39], v[72:75], v[244:247]
buffer_load_dword v38, v45, s[40:43], s16 offen
v_mfma_f32_16x16x32_bf16 v[232:235], a[40:43], v[64:67], v[232:235]
v_mfma_f32_16x16x32_bf16 v[248:251], a[40:43], v[72:75], v[248:251]
s_waitcnt vmcnt(10)
v_add3_u32 v50, v80, v81, v48
buffer_load_dwordx4 v[128:131], v44, s[40:43], s9 offen offset:0
v_mfma_f32_16x16x32_bf16 v[236:239], a[44:47], v[64:67], v[236:239]
v_add3_u32 v50, v82, v83, v50
v_mfma_f32_16x16x32_bf16 v[252:255], a[44:47], v[72:75], v[252:255]
v_add3_u32 v50, v84, v85, v50
buffer_load_dwordx4 v[136:139], v46, s[40:43], s9 offen offset:0
v_mfma_f32_16x16x32_bf16 v[224:227], a[48:51], v[68:71], v[224:227]
v_add3_u32 v50, v86, v87, v50
v_mfma_f32_16x16x32_bf16 v[240:243], a[48:51], v[76:79], v[240:243]
v_add3_u32 v50, v88, v89, v50
buffer_load_dwordx4 v[132:135], v44, s[40:43], s9 offen offset:1024
v_mfma_f32_16x16x32_bf16 v[228:231], a[52:55], v[68:71], v[228:231]
v_add3_u32 v50, v90, v91, v50
v_mfma_f32_16x16x32_bf16 v[244:247], a[52:55], v[76:79], v[244:247]
v_add3_u32 v50, v92, v93, v50
buffer_load_dwordx4 v[140:143], v46, s[40:43], s9 offen offset:1024
v_mfma_f32_16x16x32_bf16 v[232:235], a[56:59], v[68:71], v[232:235]
v_add3_u32 v50, v94, v95, v50
v_mfma_f32_16x16x32_bf16 v[248:251], a[56:59], v[76:79], v[248:251]
v_cmp_ne_u32 vcc, v50, v36
buffer_load_dword v39, v45, s[40:43], s17 offen
v_mfma_f32_16x16x32_bf16 v[236:239], a[60:63], v[68:71], v[236:239]
s_cbranch_vccnz L_rt2
L_back2:
v_mfma_f32_16x16x32_bf16 v[252:255], a[60:63], v[76:79], v[252:255]
buffer_load_dwordx4 v[144:147], v44, s[40:43], s10 offen offset:0
v_mfma_f32_16x16x32_bf16 v[224:227], a[64:67], v[80:83], v[224:227]
v_mfma_f32_16x16x32_bf16 v[240:243], a[64:67], v[88:91], v[240:243]
buffer_load_dwordx4 v[152:155], v46, s[40:43], s10 offen offset:0
v_mfma_f32_16x16x32_bf16 v[228:231], a[68:71], v[80:83], v[228:231]
v_mfma_f32_16x16x32_bf16 v[244:247], a[68:71], v[88:91], v[244:247]
buffer_load_dwordx4 v[148:151], v44, s[40:43], s10 offen offset:1024
v_mfma_f32_16x16x32_bf16 v[232:235], a[72:75], v[80:83], v[232:235]
v_mfma_f32_16x16x32_bf16 v[248:251], a[72:75], v[88:91], v[248:251]
s_waitcnt vmcnt(13)
v_add3_u32 v50, v96, v97, v48
buffer_load_dwordx4 v[156:159], v46, s[40:43], s10 offen offset:1024
v_mfma_f32_16x16x32_bf16 v[236:239], a[76:79], v[80:83], v[236:239]
v_add3_u32 v50, v98, v99, v50
v_mfma_f32_16x16x32_bf16 v[252:255], a[76:79], v[88:91], v[252:255]
v_add3_u32 v50, v100, v101, v50
buffer_load_dword v40, v45, s[40:43], s18 offen
v_mfma_f32_16x16x32_bf16 v[224:227], a[80:83], v[84:87], v[224:227]
v_add3_u32 v50, v102, v103, v50
v_mfma_f32_16x16x32_bf16 v[240:243], a[80:83], v[92:95], v[240:243]
v_add3_u32 v50, v104, v105, v50
buffer_load_dwordx4 v[160:163], v44, s[40:43], s11 offen offset:0
v_mfma_f32_16x16x32_bf16 v[228:231], a[84:87], v[84:87], v[228:231]
v_add3_u32 v50, v106, v107, v50
v_mfma_f32_16x16x32_bf16 v[244:247], a[84:87], v[92:95], v[244:247]
v_add3_u32 v50, v108, v109, v50
buffer_load_dwordx4 v[168:171], v46, s[40:43], s11 offen offset:0
v_mfma_f32_16x16x32_bf16 v[232:235], a[88:91], v[84:87], v[232:235]
v_add3_u32 v50, v110, v111, v50
v_mfma_f32_16x16x32_bf16 v[248:251], a[88:91], v[92:95], v[248:251]
v_cmp_ne_u32 vcc, v50, v37
buffer_load_dwordx4 v[164:167], v44, s[40:43], s11 offen offset:1024
v_mfma_f32_16x16x32_bf16 v[236:239], a[92:95], v[84:87], v[236:239]
s_cbranch_vccnz L_rt3
L_back3:
v_mfma_f32_16x16x32_bf16 v[252:255], a[92:95], v[92:95], v[252:255]
buffer_load_dwordx4 v[172:175], v46, s[40:43], s11 offen offset:1024
v_mfma_f32_16x16x32_bf16 v[224:227], a[96:99], v[96:99], v[224:227]
v_mfma_f32_16x16x32_bf16 v[240:243], a[96:99], v[104:107], v[240:243]
buffer_load_dword v41, v45, s[40:43], s19 offen
v_mfma_f32_16x16x32_bf16 v[228:231], a[100:103], v[96:99], v[228:231]
v_mfma_f32_16x16x32_bf16 v[244:247], a[100:103], v[104:107], v[244:247]
v_mfma_f32_16x16x32_bf16 v[232:235], a[104:107], v[96:99], v[232:235]
v_mfma_f32_16x16x32_bf16 v[248:251], a[104:107], v[104:107], v[248:251]
s_waitcnt vmcnt(15)
v_add3_u32 v50, v112, v113, v48
v_mfma_f32_16x16x32_bf16 v[236:239], a[108:111], v[96:99], v[236:239]
v_add3_u32 v50, v114, v115, v50
v_mfma_f32_16x16x32_bf16 v[252:255], a[108:111], v[104:107], v[252:255]
v_add3_u32 v50, v116, v117, v50
v_mfma_f32_16x16x32_bf16 v[224:227], a[112:115], v[100:103], v[224:227]
v_add3_u32 v50, v118, v119, v50
v_mfma_f32_16x16x32_bf16 v[240:243], a[112:115], v[108:111], v[240:243]
v_add3_u32 v50, v120, v121, v50
v_mfma_f32_16x16x32_bf16 v[228:231], a[116:119], v[100:103], v[228:231]
v_add3_u32 v50, v122, v123, v50
v_mfma_f32_16x16x32_bf16 v[244:247], a[116:119], v[108:111], v[244:247]
v_add3_u32 v50, v124, v125, v50
v_mfma_f32_16x16x32_bf16 v[232:235], a[120:123], v[100:103], v[232:235]
v_add3_u32 v50, v126, v127, v50
v_mfma_f32_16x16x32_bf16 v[248:251], a[120:123], v[108:111], v[248:251]
v_cmp_ne_u32 vcc, v50, v38
v_mfma_f32_16x16x32_bf16 v[236:239], a[124:127], v[100:103], v[236:239]
s_cbranch_vccnz L_rt4
L_back4:
v_mfma_f32_16x16x32_bf16 v[252:255], a[124:127], v[108:111], v[252:255]
v_mfma_f32_16x16x32_bf16 v[224:227], a[128:131], v[112:115], v[224:227]
v_mfma_f32_16x16x32_bf16 v[240:243], a[128:131], v[120:123], v[240:243]
v_mfma_f32_16x16x32_bf16 v[228:231], a[132:135], v[112:115], v[228:231]
v_mfma_f32_16x16x32_bf16 v[244:247], a[132:135], v[120:123], v[244:247]
v_mfma_f32_16x16x32_bf16 v[232:235], a[136:139], v[112:115], v[232:235]
v_mfma_f32_16x16x32_bf16 v[248:251], a[136:139], v[120:123], v[248:251]
s_waitcnt vmcnt(10)
v_add3_u32 v50, v128, v129, v48
v_mfma_f32_16x16x32_bf16 v[236:239], a[140:143], v[112:115], v[236:239]
v_add3_u32 v50, v130, v131, v50
v_mfma_f32_16x16x32_bf16 v[252:255], a[140:143], v[120:123], v[252:255]
v_add3_u32 v50, v132, v133, v50
v_mfma_f32_16x16x32_bf16 v[224:227], a[144:147], v[116:119], v[224:227]
v_add3_u32 v50, v134, v135, v50
v_mfma_f32_16x16x32_bf16 v[240:243], a[144:147], v[124:127], v[240:243]
v_add3_u32 v50, v136, v137, v50
v_mfma_f32_16x16x32_bf16 v[228:231], a[148:151], v[116:119], v[228:231]
v_add3_u32 v50, v138, v139, v50
v_mfma_f32_16x16x32_bf16 v[244:247], a[148:151], v[124:127], v[244:247]
v_add3_u32 v50, v140, v141, v50
v_mfma_f32_16x16x32_bf16 v[232:235], a[152:155], v[116:119], v[232:235]
v_add3_u32 v50, v142, v143, v50
v_mfma_f32_16x16x32_bf16 v[248:251], a[152:155], v[124:127], v[248:251]
v_cmp_ne_u32 vcc, v50, v39
v_mfma_f32_16x16x32_bf16 v[236:239], a[156:159], v[116:119], v[236:239]
s_cbranch_vccnz L_rt5
L_back5:
v_mfma_f32_16x16x32_bf16 v[252:255], a[156:159], v[124:127], v[252:255]
v_mfma_f32_16x16x32_bf16 v[224:227], a[160:163], v[128:131], v[224:227]
v_mfma_f32_16x16x32_bf16 v[240:243], a[160:163], v[136:139], v[240:243]
v_mfma_f32_16x16x32_bf16 v[228:231], a[164:167], v[128:131], v[228:231]
v_mfma_f32_16x16x32_bf16 v[244:247], a[164:167], v[136:139], v[244:247]
v_mfma_f32_16x16x32_bf16 v[232:235], a[168:171], v[128:131], v[232:235]
v_mfma_f32_16x16x32_bf16 v[248:251], a[168:171], v[136:139], v[248:251]
s_waitcnt vmcnt(5)
v_add3_u32 v50, v144, v145, v48
v_mfma_f32_16x16x32_bf16 v[236:239], a[172:175], v[128:131], v[236:239]
v_add3_u32 v50, v146, v147, v50
v_mfma_f32_16x16x32_bf16 v[252:255], a[172:175], v[136:139], v[252:255]
v_add3_u32 v50, v148, v149, v50
v_mfma_f32_16x16x32_bf16 v[224:227], a[176:179], v[132:135], v[224:227]
v_add3_u32 v50, v150, v151, v50
v_mfma_f32_16x16x32_bf16 v[240:243], a[176:179], v[140:143], v[240:243]
v_add3_u32 v50, v152, v153, v50
v_mfma_f32_16x16x32_bf16 v[228:231], a[180:183], v[132:135], v[228:231]
v_add3_u32 v50, v154, v155, v50
v_mfma_f32_16x16x32_bf16 v[244:247], a[180:183], v[140:143], v[244:247]
v_add3_u32 v50, v156, v157, v50
v_mfma_f32_16x16x32_bf16 v[232:235], a[184:187], v[132:135], v[232:235]
v_add3_u32 v50, v158, v159, v50
v_mfma_f32_16x16x32_bf16 v[248:251], a[184:187], v[140:143], v[248:251]
v_cmp_ne_u32 vcc, v50, v40
v_mfma_f32_16x16x32_bf16 v[236:239], a[188:191], v[132:135], v[236:239]
s_cbranch_vccnz L_rt6
L_back6:
v_mfma_f32_16x16x32_bf16 v[252:255], a[188:191], v[140:143], v[252:255]
v_mfma_f32_16x16x32_bf16 v[224:227], a[192:195], v[144:147], v[224:227]
v_mfma_f32_16x16x32_bf16 v[240:243], a[192:195], v[152:155], v[240:243]
v_mfma_f32_16x16x32_bf16 v[228:231], a[196:199], v[144:147], v[228:231]
v_mfma_f32_16x16x32_bf16 v[244:247], a[196:199], v[152:155], v[244:247]
v_mfma_f32_16x16x32_bf16 v[232:235], a[200:203], v[144:147], v[232:235]
v_mfma_f32_16x16x32_bf16 v[248:251], a[200:203], v[152:155], v[248:251]
s_waitcnt vmcnt(0)
v_add3_u32 v50, v160, v161, v48
v_mfma_f32_16x16x32_bf16 v[236:239], a[204:207], v[144:147], v[236:239]
v_add3_u32 v50, v162, v163, v50
v_mfma_f32_16x16x32_bf16 v[252:255], a[204:207], v[152:155], v[252:255]
v_add3_u32 v50, v164, v165, v50
v_mfma_f32_16x16x32_bf16 v[224:227], a[208:211], v[148:151], v[224:227]
v_add3_u32 v50, v166, v167, v50
v_mfma_f32_16x16x32_bf16 v[240:243], a[208:211], v[156:159], v[240:243]
v_add3_u32 v50, v168, v169, v50
v_mfma_f32_16x16x32_bf16 v[228:231], a[212:215], v[148:151], v[228:231]
v_add3_u32 v50, v170, v171, v50
v_mfma_f32_16x16x32_bf16 v[244:247], a[212:215], v[156:159], v[244:247]
v_add3_u32 v50, v172, v173, v50
s_cmp_lt_u32 s101, 8
s_cbranch_scc0 L_nowb
buffer_wbl2 sc1
L_nowb:
v_mfma_f32_16x16x32_bf16 v[232:235], a[216:219], v[148:151], v[232:235]
v_add3_u32 v50, v174, v175, v50
v_mfma_f32_16x16x32_bf16 v[248:251], a[216:219], v[156:159], v[248:251]
v_cmp_ne_u32 vcc, v50, v41
v_mfma_f32_16x16x32_bf16 v[236:239], a[220:223], v[148:151], v[236:239]
s_cbranch_vccnz L_rt7
L_back7:
v_mfma_f32_16x16x32_bf16 v[252:255], a[220:223], v[156:159], v[252:255]
v_mfma_f32_16x16x32_bf16 v[224:227], a[224:227], v[160:163], v[224:227]
v_mfma_f32_16x16x32_bf16 v[240:243], a[224:227], v[168:171], v[240:243]
v_mfma_f32_16x16x32_bf16 v[228:231], a[228:231], v[160:163], v[228:231]
v_mfma_f32_16x16x32_bf16 v[244:247], a[228:231], v[168:171], v[244:247]
v_mfma_f32_16x16x32_bf16 v[232:235], a[232:235], v[160:163], v[232:235]
v_mfma_f32_16x16x32_bf16 v[248:251], a[232:235], v[168:171], v[248:251]
v_mfma_f32_16x16x32_bf16 v[236:239], a[236:239], v[160:163], v[236:239]
v_mfma_f32_16x16x32_bf16 v[252:255], a[236:239], v[168:171], v[252:255]
v_mfma_f32_16x16x32_bf16 v[224:227], a[240:243], v[164:167], v[224:227]
v_mfma_f32_16x16x32_bf16 v[240:243], a[240:243], v[172:175], v[240:243]
v_mfma_f32_16x16x32_bf16 v[228:231], a[244:247], v[164:167], v[228:231]
v_mfma_f32_16x16x32_bf16 v[244:247], a[244:247], v[172:175], v[244:247]
v_mfma_f32_16x16x32_bf16 v[232:235], a[248:251], v[164:167], v[232:235]
v_mfma_f32_16x16x32_bf16 v[248:251], a[248:251], v[172:175], v[248:251]
v_mfma_f32_16x16x32_bf16 v[236:239], a[252:255], v[164:167], v[236:239]
v_mfma_f32_16x16x32_bf16 v[252:255], a[252:255], v[172:175], v[252:255]
s_nop 7
v_cvt_pk_bf16_f32 v64, v224, v225
v_cvt_pk_bf16_f32 v65, v226, v227
v_cvt_pk_bf16_f32 v66, v228, v229
v_cvt_pk_bf16_f32 v67, v230, v231
s_nop 1
v_permlane16_swap_b32 v64, v66
v_permlane16_swap_b32 v65, v67
buffer_store_dwordx4 v[64:67], v31, s[36:39], 0 offen offset:0 sc0 sc1
v_cvt_pk_bf16_f32 v68, v232, v233
v_cvt_pk_bf16_f32 v69, v234, v235
v_cvt_pk_bf16_f32 v70, v236, v237
v_cvt_pk_bf16_f32 v71, v238, v239
s_nop 1
v_permlane16_swap_b32 v68, v70
v_permlane16_swap_b32 v69, v71
buffer_store_dwordx4 v[68:71], v31, s[36:39], 0 offen offset:64 sc0 sc1
v_cvt_pk_bf16_f32 v72, v240, v241
v_cvt_pk_bf16_f32 v73, v242, v243
v_cvt_pk_bf16_f32 v74, v244, v245
v_cvt_pk_bf16_f32 v75, v246, v247
s_nop 1
v_permlane16_swap_b32 v72, v74
v_permlane16_swap_b32 v73, v75
buffer_store_dwordx4 v[72:75], v31, s[36:39], s93 offen offset:0 sc0 sc1
v_cvt_pk_bf16_f32 v76, v248, v249
v_cvt_pk_bf16_f32 v77, v250, v251
v_cvt_pk_bf16_f32 v78, v252, v253
v_cvt_pk_bf16_f32 v79, v254, v255
s_nop 1
v_permlane16_swap_b32 v76, v78
v_permlane16_swap_b32 v77, v79
buffer_store_dwordx4 v[76:79], v31, s[36:39], s93 offen offset:64 sc0 sc1
s_cmp_ge_u32 s2, 2
s_cbranch_scc1 L_noep
s_cmp_lg_u32 s47, 0
s_cbranch_scc1 L_noep
s_lshl_b32 s48, s44, 7
s_add_u32 s48, s48, 5324800
v_mov_b32 v51, 0
v_cmp_eq_u32 vcc, 0, v1
s_and_saveexec_b64 s[96:97], vcc
buffer_store_dword v48, v51, s[40:43], s48 offen sc1
s_mov_b64 exec, s[96:97]
L_noep:
L_end:
s_endpgm
L_st_remote:
buffer_store_dwordx4 v[192:195], v240, s[40:43], 0 offen offset:0 sc1
buffer_store_dwordx4 v[200:203], v240, s[40:43], s52 offen offset:0 sc1
buffer_store_dwordx4 v[196:199], v240, s[40:43], 0 offen offset:1024 sc1
buffer_store_dwordx4 v[204:207], v240, s[40:43], s52 offen offset:1024 sc1
buffer_store_dword v32, v241, s[40:43], 0 offen sc1
s_branch L_st_done
L_rt1:
s_add_u32 s62, s62, 1
s_cmp_gt_u32 s62, 20000
s_cbranch_scc1 L_back1
buffer_load_dwordx4 v[64:67], v44, s[40:43], s5 offen offset:0 sc1
buffer_load_dwordx4 v[72:75], v46, s[40:43], s5 offen offset:0 sc1
buffer_load_dwordx4 v[68:71], v44, s[40:43], s5 offen offset:1024 sc1
buffer_load_dwordx4 v[76:79], v46, s[40:43], s5 offen offset:1024 sc1
buffer_load_dword v35, v45, s[40:43], s13 offen sc1
s_waitcnt vmcnt(0)
v_add3_u32 v50, v64, v65, v48
v_add3_u32 v50, v66, v67, v50
v_add3_u32 v50, v68, v69, v50
v_add3_u32 v50, v70, v71, v50
v_add3_u32 v50, v72, v73, v50
v_add3_u32 v50, v74, v75, v50
v_add3_u32 v50, v76, v77, v50
v_add3_u32 v50, v78, v79, v50
v_cmp_ne_u32 vcc, v50, v35
s_nop 1
s_cbranch_vccnz L_rt1
s_branch L_back1
L_rt2:
s_add_u32 s62, s62, 1
s_cmp_gt_u32 s62, 20000
s_cbranch_scc1 L_back2
buffer_load_dwordx4 v[80:83], v44, s[40:43], s6 offen offset:0 sc1
buffer_load_dwordx4 v[88:91], v46, s[40:43], s6 offen offset:0 sc1
buffer_load_dwordx4 v[84:87], v44, s[40:43], s6 offen offset:1024 sc1
buffer_load_dwordx4 v[92:95], v46, s[40:43], s6 offen offset:1024 sc1
buffer_load_dword v36, v45, s[40:43], s14 offen sc1
s_waitcnt vmcnt(0)
v_add3_u32 v50, v80, v81, v48
v_add3_u32 v50, v82, v83, v50
v_add3_u32 v50, v84, v85, v50
v_add3_u32 v50, v86, v87, v50
v_add3_u32 v50, v88, v89, v50
v_add3_u32 v50, v90, v91, v50
v_add3_u32 v50, v92, v93, v50
v_add3_u32 v50, v94, v95, v50
v_cmp_ne_u32 vcc, v50, v36
s_nop 1
s_cbranch_vccnz L_rt2
s_branch L_back2
L_rt3:
s_add_u32 s62, s62, 1
s_cmp_gt_u32 s62, 20000
s_cbranch_scc1 L_back3
buffer_load_dwordx4 v[96:99], v44, s[40:43], s7 offen offset:0 sc1
buffer_load_dwordx4 v[104:107], v46, s[40:43], s7 offen offset:0 sc1
buffer_load_dwordx4 v[100:103], v44, s[40:43], s7 offen offset:1024 sc1
buffer_load_dwordx4 v[108:111], v46, s[40:43], s7 offen offset:1024 sc1
buffer_load_dword v37, v45, s[40:43], s15 offen sc1
s_waitcnt vmcnt(0)
v_add3_u32 v50, v96, v97, v48
v_add3_u32 v50, v98, v99, v50
v_add3_u32 v50, v100, v101, v50
v_add3_u32 v50, v102, v103, v50
v_add3_u32 v50, v104, v105, v50
v_add3_u32 v50, v106, v107, v50
v_add3_u32 v50, v108, v109, v50
v_add3_u32 v50, v110, v111, v50
v_cmp_ne_u32 vcc, v50, v37
s_nop 1
s_cbranch_vccnz L_rt3
s_branch L_back3
L_rt4:
s_add_u32 s62, s62, 1
s_cmp_gt_u32 s62, 20000
s_cbranch_scc1 L_back4
buffer_load_dwordx4 v[112:115], v44, s[40:43], s8 offen offset:0 sc1
buffer_load_dwordx4 v[120:123], v46, s[40:43], s8 offen offset:0 sc1
buffer_load_dwordx4 v[116:119], v44, s[40:43], s8 offen offset:1024 sc1
buffer_load_dwordx4 v[124:127], v46, s[40:43], s8 offen offset:1024 sc1
buffer_load_dword v38, v45, s[40:43], s16 offen sc1
s_waitcnt vmcnt(0)
v_add3_u32 v50, v112, v113, v48
v_add3_u32 v50, v114, v115, v50
v_add3_u32 v50, v116, v117, v50
v_add3_u32 v50, v118, v119, v50
v_add3_u32 v50, v120, v121, v50
v_add3_u32 v50, v122, v123, v50
v_add3_u32 v50, v124, v125, v50
v_add3_u32 v50, v126, v127, v50
v_cmp_ne_u32 vcc, v50, v38
s_nop 1
s_cbranch_vccnz L_rt4
s_branch L_back4
L_rt5:
s_add_u32 s62, s62, 1
s_cmp_gt_u32 s62, 20000
s_cbranch_scc1 L_back5
buffer_load_dwordx4 v[128:131], v44, s[40:43], s9 offen offset:0 sc1
buffer_load_dwordx4 v[136:139], v46, s[40:43], s9 offen offset:0 sc1
buffer_load_dwordx4 v[132:135], v44, s[40:43], s9 offen offset:1024 sc1
buffer_load_dwordx4 v[140:143], v46, s[40:43], s9 offen offset:1024 sc1
buffer_load_dword v39, v45, s[40:43], s17 offen sc1
s_waitcnt vmcnt(0)
v_add3_u32 v50, v128, v129, v48
v_add3_u32 v50, v130, v131, v50
v_add3_u32 v50, v132, v133, v50
v_add3_u32 v50, v134, v135, v50
v_add3_u32 v50, v136, v137, v50
v_add3_u32 v50, v138, v139, v50
v_add3_u32 v50, v140, v141, v50
v_add3_u32 v50, v142, v143, v50
v_cmp_ne_u32 vcc, v50, v39
s_nop 1
s_cbranch_vccnz L_rt5
s_branch L_back5
L_rt6:
s_add_u32 s62, s62, 1
s_cmp_gt_u32 s62, 20000
s_cbranch_scc1 L_back6
buffer_load_dwordx4 v[144:147], v44, s[40:43], s10 offen offset:0 sc1
buffer_load_dwordx4 v[152:155], v46, s[40:43], s10 offen offset:0 sc1
buffer_load_dwordx4 v[148:151], v44, s[40:43], s10 offen offset:1024 sc1
buffer_load_dwordx4 v[156:159], v46, s[40:43], s10 offen offset:1024 sc1
buffer_load_dword v40, v45, s[40:43], s18 offen sc1
s_waitcnt vmcnt(0)
v_add3_u32 v50, v144, v145, v48
v_add3_u32 v50, v146, v147, v50
v_add3_u32 v50, v148, v149, v50
v_add3_u32 v50, v150, v151, v50
v_add3_u32 v50, v152, v153, v50
v_add3_u32 v50, v154, v155, v50
v_add3_u32 v50, v156, v157, v50
v_add3_u32 v50, v158, v159, v50
v_cmp_ne_u32 vcc, v50, v40
s_nop 1
s_cbranch_vccnz L_rt6
s_branch L_back6
L_rt7:
s_add_u32 s62, s62, 1
s_cmp_gt_u32 s62, 20000
s_cbranch_scc1 L_back7
buffer_load_dwordx4 v[160:163], v44, s[40:43], s11 offen offset:0 sc1
buffer_load_dwordx4 v[168:171], v46, s[40:43], s11 offen offset:0 sc1
buffer_load_dwordx4 v[164:167], v44, s[40:43], s11 offen offset:1024 sc1
buffer_load_dwordx4 v[172:175], v46, s[40:43], s11 offen offset:1024 sc1
buffer_load_dword v41, v45, s[40:43], s19 offen sc1
s_waitcnt vmcnt(0)
v_add3_u32 v50, v160, v161, v48
v_add3_u32 v50, v162, v163, v50
v_add3_u32 v50, v164, v165, v50
v_add3_u32 v50, v166, v167, v50
v_add3_u32 v50, v168, v169, v50
v_add3_u32 v50, v170, v171, v50
v_add3_u32 v50, v172, v173, v50
v_add3_u32 v50, v174, v175, v50
v_cmp_ne_u32 vcc, v50, v41
s_nop 1
s_cbranch_vccnz L_rt7
s_branch L_back7
L_code_end:
.section .rodata,"a"
.p2align 6
.amdhsa_kernel concat_heads__linear_attn_block__linear_attn_block__prompt_kernel
  .amdhsa_next_free_vgpr 512
  .amdhsa_next_free_sgpr 102
  .amdhsa_accum_offset 256
  .amdhsa_group_segment_fixed_size 0
  .amdhsa_kernarg_size 72
  .amdhsa_user_sgpr_count 2
  .amdhsa_user_sgpr_kernarg_segment_ptr 1
  .amdhsa_system_sgpr_workgroup_id_x 1
.end_amdhsa_kernel
```
